```python
import torch

def _softmax(x, axis=-1):
    return torch.softmax(x, dim=axis)
def _gelu(x):
    return torch.nn.functional.gelu(x, approximate="tanh")
def _silu(x):
    return torch.nn.functional.silu(x)
def _sigmoid(x):
    return torch.sigmoid(x)
def _layernorm(x, axis=-1, eps=1e-5):
    m = x.mean(dim=axis, keepdim=True)
    v = x.var(dim=axis, keepdim=True, unbiased=False)
    return (x - m) / torch.sqrt(v + eps)
def _scatter_add(tgt, idx, src, axis=0):
    return tgt.clone().index_add_(axis, idx, src)
def _segment_sum(src, seg, n):
    out = torch.zeros((n,) + src.shape[1:], dtype=src.dtype)
    return out.index_add_(0, seg, src)
def _pad(x, pw):
    flat = tuple(v for pair in reversed(pw) for v in pair)
    return torch.nn.functional.pad(x, flat)

kernel_name = 'gated_mix__spectral_fnet__glu_gated_glu__prompt'

def setup_inputs():

    _w = (lambda a: (lambda t: t.to(torch.bfloat16) if t.is_floating_point() else t)(torch.as_tensor(a)))
    def _A_setup():
        B, S, D = 1, 2048, 640
        ns = torch.arange(S)[:, None] * torch.arange(S)[None, :]
        nd = torch.arange(D)[:, None] * torch.arange(D)[None, :]
        Ws_re = torch.cos(-2.0 * torch.pi * ns / S).to(float)
        Ws_im = torch.sin(-2.0 * torch.pi * ns / S).to(float)
        Wd_re = torch.cos(-2.0 * torch.pi * nd / D).to(float)
        Wd_im = torch.sin(-2.0 * torch.pi * nd / D).to(float)
        return {
            "x": _w((lambda *s: torch.randn(*s, dtype=torch.bfloat16) * 0.05)(B, S, D)),
            "dft_seq_re": _w(Ws_re),
            "dft_seq_im": _w(Ws_im),
            "dft_hid_re": _w(Wd_re),
            "dft_hid_im": _w(Wd_im),
        }
    _A_in = _A_setup()

    def _B_setup():
        B, S, D, F = 1, 2048, 640, 1536
        return {
            "x": _w((lambda *s: torch.randn(*s, dtype=torch.bfloat16) * 0.05)(B, S, D)),
            "w_gate": _w((lambda *s: torch.randn(*s, dtype=torch.bfloat16) * 1.6)(D, F)),
            "w_up": _w((lambda *s: torch.randn(*s, dtype=torch.bfloat16) * 0.8)(D, F)),
            "w_down": _w((lambda *s: torch.randn(*s, dtype=torch.bfloat16) * 0.8)(F, D)),
        }
    _B_in = _B_setup()

    return {
        "A_x": _A_in["x"],
        "A_dft_seq_re": _A_in["dft_seq_re"],
        "A_dft_seq_im": _A_in["dft_seq_im"],
        "A_dft_hid_re": _A_in["dft_hid_re"],
        "A_dft_hid_im": _A_in["dft_hid_im"],
        "B_x": _B_in["x"],
        "B_w_gate": _B_in["w_gate"],
        "B_w_up": _B_in["w_up"],
        "B_w_down": _B_in["w_down"],
        "gate_w": _w((lambda *s: torch.randn(*s, dtype=torch.bfloat16) * 0.05)(640) * 16.0),
    }

def reference(A_x, A_dft_seq_re, A_dft_seq_im, A_dft_hid_re, A_dft_hid_im, B_x, B_w_gate, B_w_up, B_w_down, gate_w):
    def _A_ref(x, dft_seq_re, dft_seq_im, dft_hid_re, dft_hid_im):
        a = torch.einsum("bsd,ed->bse", x, dft_hid_re)
        b = torch.einsum("bsd,ed->bse", x, dft_hid_im)
        y = torch.einsum("ts,bse->bte", dft_seq_re, a) - torch.einsum("ts,bse->bte", dft_seq_im, b)
        return y

    def _B_ref(x, w_gate, w_up, w_down):
        g = torch.einsum("bsd,df->bsf", x, w_gate)
        u = torch.einsum("bsd,df->bsf", x, w_up)
        h = _sigmoid(g) * u
        return torch.einsum("bsf,fd->bsd", h, w_down)

    x = A_x
    g = _sigmoid((x * gate_w).sum(-1, keepdims=True))
    a = _A_ref(x, A_dft_seq_re, A_dft_seq_im, A_dft_hid_re, A_dft_hid_im)
    b = _B_ref(x, B_w_gate, B_w_up, B_w_down)
    return g * a + (1 - g) * b
```

```asm
; @launch grid=(256,1,1) block=(512,1,1) lds=151552
.amdgcn_target "amdgcn-amd-amdhsa--gfx950"
.text
.globl gated_mix__spectral_fnet__glu_gated_glu__prompt_kernel
.p2align 8
.type gated_mix__spectral_fnet__glu_gated_glu__prompt_kernel,@function
gated_mix__spectral_fnet__glu_gated_glu__prompt_kernel:
    s_cmp_ge_u32 s2, 256
    s_cbranch_scc1 L_end
    s_load_dwordx16 s[4:19], s[0:1], 0
    s_load_dwordx8 s[20:27], s[0:1], 64
    s_load_dwordx2 s[28:29], s[0:1], 96
    v_lshrrev_b32 v1, 6, v0
    s_and_b32 s77, s2, 7
    s_lshr_b32 s76, s2, 3
    v_readfirstlane_b32 s75, v1
    v_and_b32 v0, 63, v0
    s_and_b32 s72, s77, 3
    s_lshr_b32 s78, s77, 2
    s_lshl_b32 s78, s78, 3
    s_lshr_b32 s73, s76, 2
    s_add_u32 s73, s73, s78
    s_and_b32 s74, s76, 3
    s_lshl_b32 s98, s72, 1
    s_add_u32 s98, s98, s74
    s_sub_u32 s98, s98, 2
    s_waitcnt lgkmcnt(0)
    s_mov_b32 s32, s4
    s_mov_b32 s33, s5
    s_mov_b32 s34, 2621440
    s_mov_b32 s35, 0x20000
    s_sub_u32 s36, s6, 4096
    s_subb_u32 s37, s7, 0
    s_mov_b32 s38, 8392704
    s_mov_b32 s39, 0x20000
    s_sub_u32 s40, s8, 4096
    s_subb_u32 s41, s9, 0
    s_mov_b32 s42, 8392704
    s_mov_b32 s43, 0x20000
    s_cmp_lt_u32 s98, 4
    s_cselect_b32 s44, s10, s12
    s_cselect_b32 s45, s11, s13
    s_cselect_b32 s93, 0, 0x80008000
    s_mov_b32 s46, 819200
    s_mov_b32 s47, 0x20000
    s_and_b32 s78, s75, 1
    s_cmp_eq_u32 s78, 0
    s_cselect_b32 s48, s16, s18
    s_cselect_b32 s49, s17, s19
    s_mov_b32 s50, 1966080
    s_mov_b32 s51, 0x20000
    s_mov_b32 s52, s20
    s_mov_b32 s53, s21
    s_mov_b32 s54, 1966080
    s_mov_b32 s55, 0x20000
    s_mov_b32 s56, s22
    s_mov_b32 s57, s23
    s_mov_b32 s58, 1280
    s_mov_b32 s59, 0x20000
    s_mov_b32 s60, s28
    s_mov_b32 s61, s29
    s_mov_b32 s62, 32546816
    s_mov_b32 s63, 0x20000
    s_mov_b32 s64, s24
    s_mov_b32 s65, s25
    s_mov_b32 s66, 2621440
    s_mov_b32 s67, 0x20000
    s_mov_b32 s68, s26
    s_mov_b32 s69, s27
    s_mov_b32 s70, 256
    s_mov_b32 s71, 0x20000
    s_cmp_ge_u32 s75, 4
    s_cbranch_scc1 L_loader
    s_branch L_consumer
L_consumer:
    v_mov_b32 v244, v0
    s_lshr_b32 s87, s75, 1
    s_and_b32 s88, s75, 1
    s_mov_b32 s84, 0
    s_mov_b32 s85, 0
    v_mov_b32 v253, 1
    s_lshl_b32 s78, s2, 7
    s_add_u32 s78, s78, 32505856
    s_lshl_b32 s79, s75, 2
    s_add_u32 s78, s78, s79
    v_mov_b32 v254, s78
    s_cmp_lg_u32 s75, 0
    s_cbranch_scc1 Lnoclr_1
    s_cmp_ge_u32 s2, 8
    s_cbranch_scc1 Lnoclr_1
    v_lshrrev_b32 v245, 2, v0
    v_lshlrev_b32 v245, 7, v245
    v_and_b32 v246, 3, v0
    v_lshl_add_u32 v245, v246, 4, v245
    s_lshl_b32 s78, s2, 12
    s_add_u32 s78, s78, 32505856
    v_mov_b32 v4, 0
    v_mov_b32 v5, 0
    v_mov_b32 v6, 0
    v_mov_b32 v7, 0
    buffer_store_dwordx4 v[4:7], v245, s[60:63], s78 offen sc1
    buffer_store_dwordx4 v[4:7], v245, s[60:63], s78 offen offset:2048 sc1
    s_lshl_b32 s78, s2, 2
    v_mov_b32 v245, s78
    s_waitcnt vmcnt(0)
    s_mov_b64 exec, 1
    buffer_store_dword v253, v245, s[68:71], 0 offen sc1
    s_mov_b64 exec, -1
Lnoclr_1:
    s_cmp_lg_u32 s75, 3
    s_cbranch_scc1 Lnz_2
    s_lshl_b32 s78, s73, 4
    s_lshl_b32 s79, s72, 2
    s_add_u32 s78, s78, s79
    s_add_u32 s78, s78, s74
    s_lshl_b32 s78, s78, 3
    v_lshrrev_b32 v245, 3, v244
    v_add_u32 v245, s78, v245
    v_and_b32 v246, 7, v244
    v_lshlrev_b32 v246, 4, v246
    v_mul_u32_u24 v247, 1280, v245
    v_add_u32 v247, v247, v246
    buffer_load_dwordx4 v[0:3], v247, s[32:35], 0 offen offset:0
    buffer_load_dwordx4 v[4:7], v247, s[32:35], 0 offen offset:128
    buffer_load_dwordx4 v[8:11], v247, s[32:35], 0 offen offset:256
    buffer_load_dwordx4 v[12:15], v247, s[32:35], 0 offen offset:384
    buffer_load_dwordx4 v[16:19], v247, s[32:35], 0 offen offset:512
    buffer_load_dwordx4 v[20:23], v247, s[32:35], 0 offen offset:640
    buffer_load_dwordx4 v[24:27], v247, s[32:35], 0 offen offset:768
    buffer_load_dwordx4 v[28:31], v247, s[32:35], 0 offen offset:896
    buffer_load_dwordx4 v[32:35], v247, s[32:35], 0 offen offset:1024
    buffer_load_dwordx4 v[36:39], v247, s[32:35], 0 offen offset:1152
    buffer_load_dwordx4 v[40:43], v246, s[56:59], 0 offen offset:0
    buffer_load_dwordx4 v[44:47], v246, s[56:59], 0 offen offset:128
    buffer_load_dwordx4 v[48:51], v246, s[56:59], 0 offen offset:256
    buffer_load_dwordx4 v[52:55], v246, s[56:59], 0 offen offset:384
    buffer_load_dwordx4 v[56:59], v246, s[56:59], 0 offen offset:512
    buffer_load_dwordx4 v[60:63], v246, s[56:59], 0 offen offset:640
    buffer_load_dwordx4 v[64:67], v246, s[56:59], 0 offen offset:768
    buffer_load_dwordx4 v[68:71], v246, s[56:59], 0 offen offset:896
    buffer_load_dwordx4 v[72:75], v246, s[56:59], 0 offen offset:1024
    buffer_load_dwordx4 v[76:79], v246, s[56:59], 0 offen offset:1152
    v_mov_b32 v80, 0
    v_mov_b32 v81, 0
    v_mov_b32 v82, 0
    v_mov_b32 v83, 0
    v_lshlrev_b32 v245, 2, v245
    v_add_u32 v245, 32538624, v245
    s_waitcnt vmcnt(0)
    v_dot2_f32_bf16 v80, v0, v40, v80
    v_dot2_f32_bf16 v81, v1, v41, v81
    v_dot2_f32_bf16 v82, v2, v42, v82
    v_dot2_f32_bf16 v83, v3, v43, v83
    v_dot2_f32_bf16 v80, v4, v44, v80
    v_dot2_f32_bf16 v81, v5, v45, v81
    v_dot2_f32_bf16 v82, v6, v46, v82
    v_dot2_f32_bf16 v83, v7, v47, v83
    v_dot2_f32_bf16 v80, v8, v48, v80
    v_dot2_f32_bf16 v81, v9, v49, v81
    v_dot2_f32_bf16 v82, v10, v50, v82
    v_dot2_f32_bf16 v83, v11, v51, v83
    v_dot2_f32_bf16 v80, v12, v52, v80
    v_dot2_f32_bf16 v81, v13, v53, v81
    v_dot2_f32_bf16 v82, v14, v54, v82
    v_dot2_f32_bf16 v83, v15, v55, v83
    v_dot2_f32_bf16 v80, v16, v56, v80
    v_dot2_f32_bf16 v81, v17, v57, v81
    v_dot2_f32_bf16 v82, v18, v58, v82
    v_dot2_f32_bf16 v83, v19, v59, v83
    v_dot2_f32_bf16 v80, v20, v60, v80
    v_dot2_f32_bf16 v81, v21, v61, v81
    v_dot2_f32_bf16 v82, v22, v62, v82
    v_dot2_f32_bf16 v83, v23, v63, v83
    v_dot2_f32_bf16 v80, v24, v64, v80
    v_dot2_f32_bf16 v81, v25, v65, v81
    v_dot2_f32_bf16 v82, v26, v66, v82
    v_dot2_f32_bf16 v83, v27, v67, v83
    v_dot2_f32_bf16 v80, v28, v68, v80
    v_dot2_f32_bf16 v81, v29, v69, v81
    v_dot2_f32_bf16 v82, v30, v70, v82
    v_dot2_f32_bf16 v83, v31, v71, v83
    v_dot2_f32_bf16 v80, v32, v72, v80
    v_dot2_f32_bf16 v81, v33, v73, v81
    v_dot2_f32_bf16 v82, v34, v74, v82
    v_dot2_f32_bf16 v83, v35, v75, v83
    v_dot2_f32_bf16 v80, v36, v76, v80
    v_dot2_f32_bf16 v81, v37, v77, v81
    v_dot2_f32_bf16 v82, v38, v78, v82
    v_dot2_f32_bf16 v83, v39, v79, v83
    s_nop 2
    v_add_f32 v80, v80, v81
    v_add_f32 v82, v82, v83
    v_add_f32 v80, v80, v82
    s_nop 1
    v_add_f32_dpp v80, v80, v80 quad_perm:[1,0,3,2] row_mask:0xf bank_mask:0xf
    s_nop 1
    v_add_f32_dpp v80, v80, v80 quad_perm:[2,3,0,1] row_mask:0xf bank_mask:0xf
    s_nop 1
    v_add_f32_dpp v80, v80, v80 row_half_mirror row_mask:0xf bank_mask:0xf
    buffer_store_dword v80, v245, s[60:63], 0 offen sc1
Lnz_2:
    s_cmp_lt_u32 s74, 2
    s_cbranch_scc0 L_cons_Y
    v_and_b32 v245, 15, v244
    v_lshrrev_b32 v246, 4, v244
    v_lshrrev_b32 v247, 1, v245
    v_xor_b32 v247, v247, v246
    v_lshlrev_b32 v247, 4, v247
    v_lshl_add_u32 v247, v245, 7, v247
    s_lshl_b32 s78, s87, 13
    v_add_u32 v224, s78, v247
    v_xor_b32 v225, 64, v224
    v_bfe_u32 v247, v244, 2, 2
    v_and_b32 v248, 3, v244
    v_lshl_add_u32 v249, v246, 3, v247
    v_lshlrev_b32 v249, 7, v249
    v_lshl_add_u32 v249, v248, 3, v249
    v_and_b32 v248, 1, v246
    v_lshrrev_b32 v247, 1, v247
    v_lshl_or_b32 v247, v248, 1, v247
    v_lshl_add_u32 v249, v247, 5, v249
    s_lshl_b32 s78, s88, 13
    s_add_u32 s78, s78, 65536
    v_add_u32 v226, s78, v249
    s_barrier
    v_add_u32 v230, s84, v224
    v_add_u32 v231, s84, v225
    v_add_u32 v232, s85, v226
    v_xor_b32 v233, 32, v232
    v_xor_b32 v234, 64, v232
    v_xor_b32 v235, 96, v232
    ds_read_b128 v[128:131], v230 offset:0
    ds_read_b128 v[132:135], v230 offset:2048
    ds_read_b128 v[136:139], v230 offset:4096
    ds_read_b128 v[140:143], v230 offset:6144
    ds_read_b64_tr_b16 v[160:161], v232 offset:0
    ds_read_b64_tr_b16 v[162:163], v232 offset:512
    ds_read_b64_tr_b16 v[164:165], v233 offset:0
    ds_read_b64_tr_b16 v[166:167], v233 offset:512
    ds_read_b64_tr_b16 v[168:169], v234 offset:0
    ds_read_b64_tr_b16 v[170:171], v234 offset:512
    ds_read_b64_tr_b16 v[172:173], v235 offset:0
    ds_read_b64_tr_b16 v[174:175], v235 offset:512
    ds_read_b64_tr_b16 v[176:177], v232 offset:4096
    ds_read_b64_tr_b16 v[178:179], v232 offset:4608
    ds_read_b64_tr_b16 v[180:181], v233 offset:4096
    ds_read_b64_tr_b16 v[182:183], v233 offset:4608
    ds_read_b64_tr_b16 v[184:185], v234 offset:4096
    ds_read_b64_tr_b16 v[186:187], v234 offset:4608
    ds_read_b64_tr_b16 v[188:189], v235 offset:4096
    ds_read_b64_tr_b16 v[190:191], v235 offset:4608
    s_add_u32 s85, s85, 20480
    s_cmp_eq_u32 s85, 81920
    s_cselect_b32 s85, 0, s85
    v_add_u32 v240, s85, v226
    v_xor_b32 v241, 32, v240
    v_xor_b32 v242, 64, v240
    v_xor_b32 v243, 96, v240
    s_mov_b32 s86, 0
    s_mov_b32 s99, 5
    s_waitcnt lgkmcnt(14)
    v_mfma_f32_16x16x32_bf16 v[0:3], v[160:163], v[128:131], 0
    s_add_u32 s84, s84, 16384
    v_mfma_f32_16x16x32_bf16 v[4:7], v[160:163], v[132:135], 0
    s_and_b32 s84, s84, 0xffff
    v_mfma_f32_16x16x32_bf16 v[8:11], v[160:163], v[136:139], 0
    v_add_u32 v230, s84, v224
    v_mfma_f32_16x16x32_bf16 v[12:15], v[160:163], v[140:143], 0
    s_add_u32 s85, s85, 20480
    s_waitcnt lgkmcnt(0)
    s_barrier
    v_mfma_f32_16x16x32_bf16 v[16:19], v[164:167], v[128:131], 0
    ds_read_b128 v[144:147], v231 offset:0
    v_mfma_f32_16x16x32_bf16 v[20:23], v[164:167], v[132:135], 0
    ds_read_b128 v[148:151], v231 offset:2048
    v_mfma_f32_16x16x32_bf16 v[24:27], v[164:167], v[136:139], 0
    ds_read_b128 v[152:155], v231 offset:4096
    v_mfma_f32_16x16x32_bf16 v[28:31], v[164:167], v[140:143], 0
    s_cmp_eq_u32 s85, 81920
    v_mfma_f32_16x16x32_bf16 v[32:35], v[168:171], v[128:131], 0
    ds_read_b128 v[156:159], v231 offset:6144
    v_mfma_f32_16x16x32_bf16 v[36:39], v[168:171], v[132:135], 0
    ds_read_b64_tr_b16 v[192:193], v240 offset:0
    v_mfma_f32_16x16x32_bf16 v[40:43], v[168:171], v[136:139], 0
    ds_read_b64_tr_b16 v[194:195], v240 offset:512
    v_mfma_f32_16x16x32_bf16 v[44:47], v[168:171], v[140:143], 0
    s_cselect_b32 s85, 0, s85
    v_mfma_f32_16x16x32_bf16 v[48:51], v[172:175], v[128:131], 0
    ds_read_b64_tr_b16 v[196:197], v241 offset:0
    v_mfma_f32_16x16x32_bf16 v[52:55], v[172:175], v[132:135], 0
    ds_read_b64_tr_b16 v[198:199], v241 offset:512
    v_mfma_f32_16x16x32_bf16 v[56:59], v[172:175], v[136:139], 0
    ds_read_b64_tr_b16 v[200:201], v242 offset:0
    v_mfma_f32_16x16x32_bf16 v[60:63], v[172:175], v[140:143], 0
    v_add_u32 v232, s85, v226
    v_mfma_f32_16x16x32_bf16 v[64:67], v[176:179], v[128:131], 0
    ds_read_b64_tr_b16 v[202:203], v242 offset:512
    v_mfma_f32_16x16x32_bf16 v[68:71], v[176:179], v[132:135], 0
    ds_read_b64_tr_b16 v[204:205], v243 offset:0
    v_mfma_f32_16x16x32_bf16 v[72:75], v[176:179], v[136:139], 0
    ds_read_b64_tr_b16 v[206:207], v243 offset:512
    v_mfma_f32_16x16x32_bf16 v[76:79], v[176:179], v[140:143], 0
    v_xor_b32 v233, 32, v232
    v_mfma_f32_16x16x32_bf16 v[80:83], v[180:183], v[128:131], 0
    ds_read_b64_tr_b16 v[208:209], v240 offset:4096
    v_mfma_f32_16x16x32_bf16 v[84:87], v[180:183], v[132:135], 0
    ds_read_b64_tr_b16 v[210:211], v240 offset:4608
    v_mfma_f32_16x16x32_bf16 v[88:91], v[180:183], v[136:139], 0
    ds_read_b64_tr_b16 v[212:213], v241 offset:4096
    v_mfma_f32_16x16x32_bf16 v[92:95], v[180:183], v[140:143], 0
    v_xor_b32 v234, 64, v232
    v_mfma_f32_16x16x32_bf16 v[96:99], v[184:187], v[128:131], 0
    ds_read_b64_tr_b16 v[214:215], v241 offset:4608
    v_mfma_f32_16x16x32_bf16 v[100:103], v[184:187], v[132:135], 0
    ds_read_b64_tr_b16 v[216:217], v242 offset:4096
    v_mfma_f32_16x16x32_bf16 v[104:107], v[184:187], v[136:139], 0
    ds_read_b64_tr_b16 v[218:219], v242 offset:4608
    v_mfma_f32_16x16x32_bf16 v[108:111], v[184:187], v[140:143], 0
    v_xor_b32 v235, 96, v232
    v_mfma_f32_16x16x32_bf16 v[112:115], v[188:191], v[128:131], 0
    ds_read_b64_tr_b16 v[220:221], v243 offset:4096
    v_mfma_f32_16x16x32_bf16 v[116:119], v[188:191], v[132:135], 0
    ds_read_b64_tr_b16 v[222:223], v243 offset:4608
    v_mfma_f32_16x16x32_bf16 v[120:123], v[188:191], v[136:139], 0
    v_mfma_f32_16x16x32_bf16 v[124:127], v[188:191], v[140:143], 0
    s_branch LB1xB_4
LB1xA_3:
    s_waitcnt lgkmcnt(14)
    v_mfma_f32_16x16x32_bf16 v[0:3], v[160:163], v[128:131], v[0:3]
    s_add_u32 s84, s84, 16384
    v_mfma_f32_16x16x32_bf16 v[4:7], v[160:163], v[132:135], v[4:7]
    s_and_b32 s84, s84, 0xffff
    v_mfma_f32_16x16x32_bf16 v[8:11], v[160:163], v[136:139], v[8:11]
    v_add_u32 v230, s84, v224
    v_mfma_f32_16x16x32_bf16 v[12:15], v[160:163], v[140:143], v[12:15]
    s_add_u32 s85, s85, 20480
    s_waitcnt lgkmcnt(0)
    s_barrier
    v_mfma_f32_16x16x32_bf16 v[16:19], v[164:167], v[128:131], v[16:19]
    ds_read_b128 v[144:147], v231 offset:0
    v_mfma_f32_16x16x32_bf16 v[20:23], v[164:167], v[132:135], v[20:23]
    ds_read_b128 v[148:151], v231 offset:2048
    v_mfma_f32_16x16x32_bf16 v[24:27], v[164:167], v[136:139], v[24:27]
    ds_read_b128 v[152:155], v231 offset:4096
    v_mfma_f32_16x16x32_bf16 v[28:31], v[164:167], v[140:143], v[28:31]
    s_cmp_eq_u32 s85, 81920
    v_mfma_f32_16x16x32_bf16 v[32:35], v[168:171], v[128:131], v[32:35]
    ds_read_b128 v[156:159], v231 offset:6144
    v_mfma_f32_16x16x32_bf16 v[36:39], v[168:171], v[132:135], v[36:39]
    ds_read_b64_tr_b16 v[192:193], v240 offset:0
    v_mfma_f32_16x16x32_bf16 v[40:43], v[168:171], v[136:139], v[40:43]
    ds_read_b64_tr_b16 v[194:195], v240 offset:512
    v_mfma_f32_16x16x32_bf16 v[44:47], v[168:171], v[140:143], v[44:47]
    s_cselect_b32 s85, 0, s85
    v_mfma_f32_16x16x32_bf16 v[48:51], v[172:175], v[128:131], v[48:51]
    ds_read_b64_tr_b16 v[196:197], v241 offset:0
    v_mfma_f32_16x16x32_bf16 v[52:55], v[172:175], v[132:135], v[52:55]
    ds_read_b64_tr_b16 v[198:199], v241 offset:512
    v_mfma_f32_16x16x32_bf16 v[56:59], v[172:175], v[136:139], v[56:59]
    ds_read_b64_tr_b16 v[200:201], v242 offset:0
    v_mfma_f32_16x16x32_bf16 v[60:63], v[172:175], v[140:143], v[60:63]
    v_add_u32 v232, s85, v226
    v_mfma_f32_16x16x32_bf16 v[64:67], v[176:179], v[128:131], v[64:67]
    ds_read_b64_tr_b16 v[202:203], v242 offset:512
    v_mfma_f32_16x16x32_bf16 v[68:71], v[176:179], v[132:135], v[68:71]
    ds_read_b64_tr_b16 v[204:205], v243 offset:0
    v_mfma_f32_16x16x32_bf16 v[72:75], v[176:179], v[136:139], v[72:75]
    ds_read_b64_tr_b16 v[206:207], v243 offset:512
    v_mfma_f32_16x16x32_bf16 v[76:79], v[176:179], v[140:143], v[76:79]
    v_xor_b32 v233, 32, v232
    v_mfma_f32_16x16x32_bf16 v[80:83], v[180:183], v[128:131], v[80:83]
    ds_read_b64_tr_b16 v[208:209], v240 offset:4096
    v_mfma_f32_16x16x32_bf16 v[84:87], v[180:183], v[132:135], v[84:87]
    ds_read_b64_tr_b16 v[210:211], v240 offset:4608
    v_mfma_f32_16x16x32_bf16 v[88:91], v[180:183], v[136:139], v[88:91]
    ds_read_b64_tr_b16 v[212:213], v241 offset:4096
    v_mfma_f32_16x16x32_bf16 v[92:95], v[180:183], v[140:143], v[92:95]
    v_xor_b32 v234, 64, v232
    v_mfma_f32_16x16x32_bf16 v[96:99], v[184:187], v[128:131], v[96:99]
    ds_read_b64_tr_b16 v[214:215], v241 offset:4608
    v_mfma_f32_16x16x32_bf16 v[100:103], v[184:187], v[132:135], v[100:103]
    ds_read_b64_tr_b16 v[216:217], v242 offset:4096
    v_mfma_f32_16x16x32_bf16 v[104:107], v[184:187], v[136:139], v[104:107]
    ds_read_b64_tr_b16 v[218:219], v242 offset:4608
    v_mfma_f32_16x16x32_bf16 v[108:111], v[184:187], v[140:143], v[108:111]
    v_xor_b32 v235, 96, v232
    v_mfma_f32_16x16x32_bf16 v[112:115], v[188:191], v[128:131], v[112:115]
    ds_read_b64_tr_b16 v[220:221], v243 offset:4096
    v_mfma_f32_16x16x32_bf16 v[116:119], v[188:191], v[132:135], v[116:119]
    ds_read_b64_tr_b16 v[222:223], v243 offset:4608
    v_mfma_f32_16x16x32_bf16 v[120:123], v[188:191], v[136:139], v[120:123]
    v_mfma_f32_16x16x32_bf16 v[124:127], v[188:191], v[140:143], v[124:127]
LB1xB_4:
    s_waitcnt lgkmcnt(14)
    v_mfma_f32_16x16x32_bf16 v[0:3], v[192:195], v[144:147], v[0:3]
    v_add_u32 v231, s84, v225
    v_mfma_f32_16x16x32_bf16 v[4:7], v[192:195], v[148:151], v[4:7]
    s_add_u32 s85, s85, 20480
    v_mfma_f32_16x16x32_bf16 v[8:11], v[192:195], v[152:155], v[8:11]
    s_cmp_eq_u32 s85, 81920
    v_mfma_f32_16x16x32_bf16 v[12:15], v[192:195], v[156:159], v[12:15]
    s_cselect_b32 s85, 0, s85
    s_waitcnt lgkmcnt(0)
    s_barrier
    v_mfma_f32_16x16x32_bf16 v[16:19], v[196:199], v[144:147], v[16:19]
    ds_read_b128 v[128:131], v230 offset:0
    v_mfma_f32_16x16x32_bf16 v[20:23], v[196:199], v[148:151], v[20:23]
    ds_read_b128 v[132:135], v230 offset:2048
    v_mfma_f32_16x16x32_bf16 v[24:27], v[196:199], v[152:155], v[24:27]
    ds_read_b128 v[136:139], v230 offset:4096
    v_mfma_f32_16x16x32_bf16 v[28:31], v[196:199], v[156:159], v[28:31]
    v_add_u32 v240, s85, v226
    v_mfma_f32_16x16x32_bf16 v[32:35], v[200:203], v[144:147], v[32:35]
    ds_read_b128 v[140:143], v230 offset:6144
    v_mfma_f32_16x16x32_bf16 v[36:39], v[200:203], v[148:151], v[36:39]
    ds_read_b64_tr_b16 v[160:161], v232 offset:0
    v_mfma_f32_16x16x32_bf16 v[40:43], v[200:203], v[152:155], v[40:43]
    ds_read_b64_tr_b16 v[162:163], v232 offset:512
    v_mfma_f32_16x16x32_bf16 v[44:47], v[200:203], v[156:159], v[44:47]
    v_xor_b32 v241, 32, v240
    v_mfma_f32_16x16x32_bf16 v[48:51], v[204:207], v[144:147], v[48:51]
    ds_read_b64_tr_b16 v[164:165], v233 offset:0
    v_mfma_f32_16x16x32_bf16 v[52:55], v[204:207], v[148:151], v[52:55]
    ds_read_b64_tr_b16 v[166:167], v233 offset:512
    v_mfma_f32_16x16x32_bf16 v[56:59], v[204:207], v[152:155], v[56:59]
    ds_read_b64_tr_b16 v[168:169], v234 offset:0
    v_mfma_f32_16x16x32_bf16 v[60:63], v[204:207], v[156:159], v[60:63]
    v_xor_b32 v242, 64, v240
    v_mfma_f32_16x16x32_bf16 v[64:67], v[208:211], v[144:147], v[64:67]
    ds_read_b64_tr_b16 v[170:171], v234 offset:512
    v_mfma_f32_16x16x32_bf16 v[68:71], v[208:211], v[148:151], v[68:71]
    ds_read_b64_tr_b16 v[172:173], v235 offset:0
    v_mfma_f32_16x16x32_bf16 v[72:75], v[208:211], v[152:155], v[72:75]
    ds_read_b64_tr_b16 v[174:175], v235 offset:512
    v_mfma_f32_16x16x32_bf16 v[76:79], v[208:211], v[156:159], v[76:79]
    v_xor_b32 v243, 96, v240
    v_mfma_f32_16x16x32_bf16 v[80:83], v[212:215], v[144:147], v[80:83]
    ds_read_b64_tr_b16 v[176:177], v232 offset:4096
    v_mfma_f32_16x16x32_bf16 v[84:87], v[212:215], v[148:151], v[84:87]
    ds_read_b64_tr_b16 v[178:179], v232 offset:4608
    v_mfma_f32_16x16x32_bf16 v[88:91], v[212:215], v[152:155], v[88:91]
    ds_read_b64_tr_b16 v[180:181], v233 offset:4096
    v_mfma_f32_16x16x32_bf16 v[92:95], v[212:215], v[156:159], v[92:95]
    s_add_u32 s86, s86, 1
    v_mfma_f32_16x16x32_bf16 v[96:99], v[216:219], v[144:147], v[96:99]
    ds_read_b64_tr_b16 v[182:183], v233 offset:4608
    v_mfma_f32_16x16x32_bf16 v[100:103], v[216:219], v[148:151], v[100:103]
    ds_read_b64_tr_b16 v[184:185], v234 offset:4096
    v_mfma_f32_16x16x32_bf16 v[104:107], v[216:219], v[152:155], v[104:107]
    ds_read_b64_tr_b16 v[186:187], v234 offset:4608
    v_mfma_f32_16x16x32_bf16 v[108:111], v[216:219], v[156:159], v[108:111]
    s_cmp_lt_u32 s86, s99
    v_mfma_f32_16x16x32_bf16 v[112:115], v[220:223], v[144:147], v[112:115]
    ds_read_b64_tr_b16 v[188:189], v235 offset:4096
    v_mfma_f32_16x16x32_bf16 v[116:119], v[220:223], v[148:151], v[116:119]
    ds_read_b64_tr_b16 v[190:191], v235 offset:4608
    v_mfma_f32_16x16x32_bf16 v[120:123], v[220:223], v[152:155], v[120:123]
    v_mfma_f32_16x16x32_bf16 v[124:127], v[220:223], v[156:159], v[124:127]
    s_cbranch_scc1 LB1xA_3
    s_cmp_eq_u32 s99, 10
    s_cbranch_scc1 LB1xX_5
    s_mov_b32 s99, 10
    s_waitcnt vmcnt(0)
    buffer_store_dword v253, v254, s[60:63], 0 offen offset:48 sc1
    s_branch LB1xA_3
LB1xX_5:
    s_cmp_eq_u32 s85, 0
    s_cselect_b32 s85, 81920, s85
    s_sub_u32 s85, s85, 20480
    s_nop 7
    s_waitcnt lgkmcnt(0)
    v_and_b32 v245, 15, v244
    v_lshlrev_b32 v245, 2, v245
    s_lshl_b32 s78, s87, 8
    v_add_u32 v245, s78, v245
    v_add_u32 v245, 147456, v245
    ds_read_b32 v240, v245 offset:2048
    ds_read_b32 v241, v245 offset:2112
    ds_read_b32 v242, v245 offset:2176
    ds_read_b32 v243, v245 offset:2240
    s_lshl_b32 s78, s72, 6
    s_xor_b32 s79, s78, 0
    v_add_u32 v246, s79, v245
    ds_read_b32 v236, v246 offset:2560
    s_xor_b32 s79, s78, 64
    v_add_u32 v246, s79, v245
    ds_read_b32 v237, v246 offset:2560
    s_xor_b32 s79, s78, 128
    v_add_u32 v246, s79, v245
    ds_read_b32 v238, v246 offset:2560
    s_xor_b32 s79, s78, 192
    v_add_u32 v246, s79, v245
    ds_read_b32 v239, v246 offset:2560
    s_mul_i32 s78, s72, 6
    s_lshl_b32 s79, s74, 1
    s_add_u32 s78, s78, s79
    s_add_u32 s78, s78, s88
    s_lshl_b32 s78, s78, 1
    s_mul_i32 s79, s73, 48
    s_add_u32 s78, s78, s79
    s_lshl_b32 s78, s78, 3
    s_lshl_b32 s79, s87, 2
    s_add_u32 s78, s78, s79
    s_lshl_b32 s94, s78, 10
    s_add_u32 s94, s94, 5242880
    s_add_u32 s95, s94, 8192
    v_lshlrev_b32 v252, 4, v244
    s_mov_b32 s83, 0xbfb8aa3b
    s_waitcnt lgkmcnt(0)
    v_mul_f32 v0, s83, v0
    v_mul_f32 v1, s83, v1
    v_mul_f32 v2, s83, v2
    v_mul_f32 v3, s83, v3
    v_mul_f32 v16, s83, v16
    v_mul_f32 v17, s83, v17
    v_mul_f32 v18, s83, v18
    v_mul_f32 v19, s83, v19
    v_exp_f32 v0, v0
    v_exp_f32 v1, v1
    v_exp_f32 v2, v2
    v_exp_f32 v3, v3
    v_exp_f32 v16, v16
    v_exp_f32 v17, v17
    v_exp_f32 v18, v18
    v_exp_f32 v19, v19
    v_fma_f32 v0, v0, v240, v240
    v_fma_f32 v1, v1, v240, v240
    v_fma_f32 v2, v2, v240, v240
    v_fma_f32 v3, v3, v240, v240
    v_fma_f32 v16, v16, v240, v240
    v_fma_f32 v17, v17, v240, v240
    v_fma_f32 v18, v18, v240, v240
    v_fma_f32 v19, v19, v240, v240
    v_rcp_f32 v0, v0
    v_rcp_f32 v1, v1
    v_rcp_f32 v2, v2
    v_rcp_f32 v3, v3
    v_rcp_f32 v16, v16
    v_rcp_f32 v17, v17
    v_rcp_f32 v18, v18
    v_rcp_f32 v19, v19
    v_mul_f32 v0, v0, v64
    v_mul_f32 v1, v1, v65
    v_mul_f32 v2, v2, v66
    v_mul_f32 v3, v3, v67
    v_mul_f32 v16, v16, v80
    v_mul_f32 v17, v17, v81
    v_mul_f32 v18, v18, v82
    v_mul_f32 v19, v19, v83
    v_cvt_pk_bf16_f32 v192, v0, v1
    v_cvt_pk_bf16_f32 v193, v2, v3
    v_cvt_pk_bf16_f32 v194, v16, v17
    v_cvt_pk_bf16_f32 v195, v18, v19
    buffer_store_dwordx4 v[192:195], v252, s[60:63], s94 offen sc1
    v_mul_f32 v4, s83, v4
    v_mul_f32 v5, s83, v5
    v_mul_f32 v6, s83, v6
    v_mul_f32 v7, s83, v7
    v_mul_f32 v20, s83, v20
    v_mul_f32 v21, s83, v21
    v_mul_f32 v22, s83, v22
    v_mul_f32 v23, s83, v23
    v_exp_f32 v4, v4
    v_exp_f32 v5, v5
    v_exp_f32 v6, v6
    v_exp_f32 v7, v7
    v_exp_f32 v20, v20
    v_exp_f32 v21, v21
    v_exp_f32 v22, v22
    v_exp_f32 v23, v23
    v_fma_f32 v4, v4, v241, v241
    v_fma_f32 v5, v5, v241, v241
    v_fma_f32 v6, v6, v241, v241
    v_fma_f32 v7, v7, v241, v241
    v_fma_f32 v20, v20, v241, v241
    v_fma_f32 v21, v21, v241, v241
    v_fma_f32 v22, v22, v241, v241
    v_fma_f32 v23, v23, v241, v241
    v_rcp_f32 v4, v4
    v_rcp_f32 v5, v5
    v_rcp_f32 v6, v6
    v_rcp_f32 v7, v7
    v_rcp_f32 v20, v20
    v_rcp_f32 v21, v21
    v_rcp_f32 v22, v22
    v_rcp_f32 v23, v23
    v_mul_f32 v4, v4, v68
    v_mul_f32 v5, v5, v69
    v_mul_f32 v6, v6, v70
    v_mul_f32 v7, v7, v71
    v_mul_f32 v20, v20, v84
    v_mul_f32 v21, v21, v85
    v_mul_f32 v22, v22, v86
    v_mul_f32 v23, v23, v87
    v_cvt_pk_bf16_f32 v196, v4, v5
    v_cvt_pk_bf16_f32 v197, v6, v7
    v_cvt_pk_bf16_f32 v198, v20, v21
    v_cvt_pk_bf16_f32 v199, v22, v23
    buffer_store_dwordx4 v[196:199], v252, s[60:63], s94 offen offset:1024 sc1
    v_mul_f32 v8, s83, v8
    v_mul_f32 v9, s83, v9
    v_mul_f32 v10, s83, v10
    v_mul_f32 v11, s83, v11
    v_mul_f32 v24, s83, v24
    v_mul_f32 v25, s83, v25
    v_mul_f32 v26, s83, v26
    v_mul_f32 v27, s83, v27
    v_exp_f32 v8, v8
    v_exp_f32 v9, v9
    v_exp_f32 v10, v10
    v_exp_f32 v11, v11
    v_exp_f32 v24, v24
    v_exp_f32 v25, v25
    v_exp_f32 v26, v26
    v_exp_f32 v27, v27
    v_fma_f32 v8, v8, v242, v242
    v_fma_f32 v9, v9, v242, v242
    v_fma_f32 v10, v10, v242, v242
    v_fma_f32 v11, v11, v242, v242
    v_fma_f32 v24, v24, v242, v242
    v_fma_f32 v25, v25, v242, v242
    v_fma_f32 v26, v26, v242, v242
    v_fma_f32 v27, v27, v242, v242
    v_rcp_f32 v8, v8
    v_rcp_f32 v9, v9
    v_rcp_f32 v10, v10
    v_rcp_f32 v11, v11
    v_rcp_f32 v24, v24
    v_rcp_f32 v25, v25
    v_rcp_f32 v26, v26
    v_rcp_f32 v27, v27
    v_mul_f32 v8, v8, v72
    v_mul_f32 v9, v9, v73
    v_mul_f32 v10, v10, v74
    v_mul_f32 v11, v11, v75
    v_mul_f32 v24, v24, v88
    v_mul_f32 v25, v25, v89
    v_mul_f32 v26, v26, v90
    v_mul_f32 v27, v27, v91
    v_cvt_pk_bf16_f32 v200, v8, v9
    v_cvt_pk_bf16_f32 v201, v10, v11
    v_cvt_pk_bf16_f32 v202, v24, v25
    v_cvt_pk_bf16_f32 v203, v26, v27
    buffer_store_dwordx4 v[200:203], v252, s[60:63], s94 offen offset:2048 sc1
    v_mul_f32 v12, s83, v12
    v_mul_f32 v13, s83, v13
    v_mul_f32 v14, s83, v14
    v_mul_f32 v15, s83, v15
    v_mul_f32 v28, s83, v28
    v_mul_f32 v29, s83, v29
    v_mul_f32 v30, s83, v30
    v_mul_f32 v31, s83, v31
    v_exp_f32 v12, v12
    v_exp_f32 v13, v13
    v_exp_f32 v14, v14
    v_exp_f32 v15, v15
    v_exp_f32 v28, v28
    v_exp_f32 v29, v29
    v_exp_f32 v30, v30
    v_exp_f32 v31, v31
    v_fma_f32 v12, v12, v243, v243
    v_fma_f32 v13, v13, v243, v243
    v_fma_f32 v14, v14, v243, v243
    v_fma_f32 v15, v15, v243, v243
    v_fma_f32 v28, v28, v243, v243
    v_fma_f32 v29, v29, v243, v243
    v_fma_f32 v30, v30, v243, v243
    v_fma_f32 v31, v31, v243, v243
    v_rcp_f32 v12, v12
    v_rcp_f32 v13, v13
    v_rcp_f32 v14, v14
    v_rcp_f32 v15, v15
    v_rcp_f32 v28, v28
    v_rcp_f32 v29, v29
    v_rcp_f32 v30, v30
    v_rcp_f32 v31, v31
    v_mul_f32 v12, v12, v76
    v_mul_f32 v13, v13, v77
    v_mul_f32 v14, v14, v78
    v_mul_f32 v15, v15, v79
    v_mul_f32 v28, v28, v92
    v_mul_f32 v29, v29, v93
    v_mul_f32 v30, v30, v94
    v_mul_f32 v31, v31, v95
    v_cvt_pk_bf16_f32 v204, v12, v13
    v_cvt_pk_bf16_f32 v205, v14, v15
    v_cvt_pk_bf16_f32 v206, v28, v29
    v_cvt_pk_bf16_f32 v207, v30, v31
    buffer_store_dwordx4 v[204:207], v252, s[60:63], s94 offen offset:3072 sc1
    v_mul_f32 v32, s83, v32
    v_mul_f32 v33, s83, v33
    v_mul_f32 v34, s83, v34
    v_mul_f32 v35, s83, v35
    v_mul_f32 v48, s83, v48
    v_mul_f32 v49, s83, v49
    v_mul_f32 v50, s83, v50
    v_mul_f32 v51, s83, v51
    v_exp_f32 v32, v32
    v_exp_f32 v33, v33
    v_exp_f32 v34, v34
    v_exp_f32 v35, v35
    v_exp_f32 v48, v48
    v_exp_f32 v49, v49
    v_exp_f32 v50, v50
    v_exp_f32 v51, v51
    v_fma_f32 v32, v32, v240, v240
    v_fma_f32 v33, v33, v240, v240
    v_fma_f32 v34, v34, v240, v240
    v_fma_f32 v35, v35, v240, v240
    v_fma_f32 v48, v48, v240, v240
    v_fma_f32 v49, v49, v240, v240
    v_fma_f32 v50, v50, v240, v240
    v_fma_f32 v51, v51, v240, v240
    v_rcp_f32 v32, v32
    v_rcp_f32 v33, v33
    v_rcp_f32 v34, v34
    v_rcp_f32 v35, v35
    v_rcp_f32 v48, v48
    v_rcp_f32 v49, v49
    v_rcp_f32 v50, v50
    v_rcp_f32 v51, v51
    v_mul_f32 v32, v32, v96
    v_mul_f32 v33, v33, v97
    v_mul_f32 v34, v34, v98
    v_mul_f32 v35, v35, v99
    v_mul_f32 v48, v48, v112
    v_mul_f32 v49, v49, v113
    v_mul_f32 v50, v50, v114
    v_mul_f32 v51, v51, v115
    v_cvt_pk_bf16_f32 v208, v32, v33
    v_cvt_pk_bf16_f32 v209, v34, v35
    v_cvt_pk_bf16_f32 v210, v48, v49
    v_cvt_pk_bf16_f32 v211, v50, v51
    buffer_store_dwordx4 v[208:211], v252, s[60:63], s95 offen sc1
    v_mul_f32 v36, s83, v36
    v_mul_f32 v37, s83, v37
    v_mul_f32 v38, s83, v38
    v_mul_f32 v39, s83, v39
    v_mul_f32 v52, s83, v52
    v_mul_f32 v53, s83, v53
    v_mul_f32 v54, s83, v54
    v_mul_f32 v55, s83, v55
    v_exp_f32 v36, v36
    v_exp_f32 v37, v37
    v_exp_f32 v38, v38
    v_exp_f32 v39, v39
    v_exp_f32 v52, v52
    v_exp_f32 v53, v53
    v_exp_f32 v54, v54
    v_exp_f32 v55, v55
    v_fma_f32 v36, v36, v241, v241
    v_fma_f32 v37, v37, v241, v241
    v_fma_f32 v38, v38, v241, v241
    v_fma_f32 v39, v39, v241, v241
    v_fma_f32 v52, v52, v241, v241
    v_fma_f32 v53, v53, v241, v241
    v_fma_f32 v54, v54, v241, v241
    v_fma_f32 v55, v55, v241, v241
    v_rcp_f32 v36, v36
    v_rcp_f32 v37, v37
    v_rcp_f32 v38, v38
    v_rcp_f32 v39, v39
    v_rcp_f32 v52, v52
    v_rcp_f32 v53, v53
    v_rcp_f32 v54, v54
    v_rcp_f32 v55, v55
    v_mul_f32 v36, v36, v100
    v_mul_f32 v37, v37, v101
    v_mul_f32 v38, v38, v102
    v_mul_f32 v39, v39, v103
    v_mul_f32 v52, v52, v116
    v_mul_f32 v53, v53, v117
    v_mul_f32 v54, v54, v118
    v_mul_f32 v55, v55, v119
    v_cvt_pk_bf16_f32 v212, v36, v37
    v_cvt_pk_bf16_f32 v213, v38, v39
    v_cvt_pk_bf16_f32 v214, v52, v53
    v_cvt_pk_bf16_f32 v215, v54, v55
    buffer_store_dwordx4 v[212:215], v252, s[60:63], s95 offen offset:1024 sc1
    v_mul_f32 v40, s83, v40
    v_mul_f32 v41, s83, v41
    v_mul_f32 v42, s83, v42
    v_mul_f32 v43, s83, v43
    v_mul_f32 v56, s83, v56
    v_mul_f32 v57, s83, v57
    v_mul_f32 v58, s83, v58
    v_mul_f32 v59, s83, v59
    v_exp_f32 v40, v40
    v_exp_f32 v41, v41
    v_exp_f32 v42, v42
    v_exp_f32 v43, v43
    v_exp_f32 v56, v56
    v_exp_f32 v57, v57
    v_exp_f32 v58, v58
    v_exp_f32 v59, v59
    v_fma_f32 v40, v40, v242, v242
    v_fma_f32 v41, v41, v242, v242
    v_fma_f32 v42, v42, v242, v242
    v_fma_f32 v43, v43, v242, v242
    v_fma_f32 v56, v56, v242, v242
    v_fma_f32 v57, v57, v242, v242
    v_fma_f32 v58, v58, v242, v242
    v_fma_f32 v59, v59, v242, v242
    v_rcp_f32 v40, v40
    v_rcp_f32 v41, v41
    v_rcp_f32 v42, v42
    v_rcp_f32 v43, v43
    v_rcp_f32 v56, v56
    v_rcp_f32 v57, v57
    v_rcp_f32 v58, v58
    v_rcp_f32 v59, v59
    v_mul_f32 v40, v40, v104
    v_mul_f32 v41, v41, v105
    v_mul_f32 v42, v42, v106
    v_mul_f32 v43, v43, v107
    v_mul_f32 v56, v56, v120
    v_mul_f32 v57, v57, v121
    v_mul_f32 v58, v58, v122
    v_mul_f32 v59, v59, v123
    v_cvt_pk_bf16_f32 v216, v40, v41
    v_cvt_pk_bf16_f32 v217, v42, v43
    v_cvt_pk_bf16_f32 v218, v56, v57
    v_cvt_pk_bf16_f32 v219, v58, v59
    buffer_store_dwordx4 v[216:219], v252, s[60:63], s95 offen offset:2048 sc1
    v_mul_f32 v44, s83, v44
    v_mul_f32 v45, s83, v45
    v_mul_f32 v46, s83, v46
    v_mul_f32 v47, s83, v47
    v_mul_f32 v60, s83, v60
    v_mul_f32 v61, s83, v61
    v_mul_f32 v62, s83, v62
    v_mul_f32 v63, s83, v63
    v_exp_f32 v44, v44
    v_exp_f32 v45, v45
    v_exp_f32 v46, v46
    v_exp_f32 v47, v47
    v_exp_f32 v60, v60
    v_exp_f32 v61, v61
    v_exp_f32 v62, v62
    v_exp_f32 v63, v63
    v_fma_f32 v44, v44, v243, v243
    v_fma_f32 v45, v45, v243, v243
    v_fma_f32 v46, v46, v243, v243
    v_fma_f32 v47, v47, v243, v243
    v_fma_f32 v60, v60, v243, v243
    v_fma_f32 v61, v61, v243, v243
    v_fma_f32 v62, v62, v243, v243
    v_fma_f32 v63, v63, v243, v243
    v_rcp_f32 v44, v44
    v_rcp_f32 v45, v45
    v_rcp_f32 v46, v46
    v_rcp_f32 v47, v47
    v_rcp_f32 v60, v60
    v_rcp_f32 v61, v61
    v_rcp_f32 v62, v62
    v_rcp_f32 v63, v63
    v_mul_f32 v44, v44, v108
    v_mul_f32 v45, v45, v109
    v_mul_f32 v46, v46, v110
    v_mul_f32 v47, v47, v111
    v_mul_f32 v60, v60, v124
    v_mul_f32 v61, v61, v125
    v_mul_f32 v62, v62, v126
    v_mul_f32 v63, v63, v127
    v_cvt_pk_bf16_f32 v220, v44, v45
    v_cvt_pk_bf16_f32 v221, v46, v47
    v_cvt_pk_bf16_f32 v222, v60, v61
    v_cvt_pk_bf16_f32 v223, v62, v63
    buffer_store_dwordx4 v[220:223], v252, s[60:63], s95 offen offset:3072 sc1
    s_branch L_cons_p2
L_cons_Y:
    v_and_b32 v245, 15, v244
    v_lshrrev_b32 v246, 4, v244
    v_lshrrev_b32 v247, 2, v245
    v_and_b32 v248, 3, v245
    v_lshl_add_u32 v249, v247, 3, v248
    v_lshrrev_b32 v248, 1, v248
    v_mul_u32_u24 v248, 3, v248
    v_and_b32 v247, 1, v247
    v_lshl_or_b32 v248, v247, 2, v248
    v_xor_b32 v248, v248, v246
    v_lshlrev_b32 v248, 4, v248
    v_lshl_add_u32 v248, v249, 7, v248
    s_lshl_b32 s78, s87, 13
    v_add_u32 v216, s78, v248
    v_xor_b32 v217, 64, v216
    v_lshrrev_b32 v247, 1, v245
    v_xor_b32 v247, v247, v246
    v_lshlrev_b32 v247, 4, v247
    v_lshl_add_u32 v247, v245, 7, v247
    s_mul_i32 s78, s88, 10240
    s_add_u32 s78, s78, 65536
    v_add_u32 v218, s78, v247
    v_xor_b32 v219, 64, v218
    v_and_b32 v245, 15, v244
    v_lshrrev_b32 v246, 4, v244
    v_lshrrev_b32 v247, 1, v245
    v_and_b32 v248, 4, v247
    v_and_b32 v247, 1, v247
    v_mul_u32_u24 v247, 3, v247
    v_or_b32 v247, v247, v248
    v_xor_b32 v247, v247, v246
    v_lshlrev_b32 v247, 4, v247
    v_lshl_add_u32 v247, v245, 7, v247
    s_lshl_b32 s78, s87, 13
    v_add_u32 v224, s78, v247
    v_xor_b32 v225, 64, v224
    v_bfe_u32 v247, v244, 2, 2
    v_and_b32 v248, 3, v244
    v_lshl_add_u32 v249, v246, 3, v247
    v_lshlrev_b32 v249, 7, v249
    v_lshl_add_u32 v249, v248, 3, v249
    v_and_b32 v248, 1, v246
    v_lshrrev_b32 v247, 1, v247
    v_lshl_or_b32 v247, v248, 1, v247
    v_lshl_add_u32 v249, v247, 5, v249
    s_lshl_b32 s78, s88, 6
    v_xor_b32 v249, s78, v249
    v_add_u32 v226, 65536, v249
    v_mov_b32 v80, 0
    v_mov_b32 v81, 0
    v_mov_b32 v82, 0
    v_mov_b32 v83, 0
    v_mov_b32 v84, 0
    v_mov_b32 v85, 0
    v_mov_b32 v86, 0
    v_mov_b32 v87, 0
    v_mov_b32 v88, 0
    v_mov_b32 v89, 0
    v_mov_b32 v90, 0
    v_mov_b32 v91, 0
    v_mov_b32 v92, 0
    v_mov_b32 v93, 0
    v_mov_b32 v94, 0
    v_mov_b32 v95, 0
    v_mov_b32 v96, 0
    v_mov_b32 v97, 0
    v_mov_b32 v98, 0
    v_mov_b32 v99, 0
    v_mov_b32 v100, 0
    v_mov_b32 v101, 0
    v_mov_b32 v102, 0
    v_mov_b32 v103, 0
    v_mov_b32 v104, 0
    v_mov_b32 v105, 0
    v_mov_b32 v106, 0
    v_mov_b32 v107, 0
    v_mov_b32 v108, 0
    v_mov_b32 v109, 0
    v_mov_b32 v110, 0
    v_mov_b32 v111, 0
    v_mov_b32 v112, 0
    v_mov_b32 v113, 0
    v_mov_b32 v114, 0
    v_mov_b32 v115, 0
    v_mov_b32 v116, 0
    v_mov_b32 v117, 0
    v_mov_b32 v118, 0
    v_mov_b32 v119, 0
    v_mov_b32 v120, 0
    v_mov_b32 v121, 0
    v_mov_b32 v122, 0
    v_mov_b32 v123, 0
    v_mov_b32 v124, 0
    v_mov_b32 v125, 0
    v_mov_b32 v126, 0
    v_mov_b32 v127, 0
    v_mov_b32 v128, 0
    v_mov_b32 v129, 0
    v_mov_b32 v130, 0
    v_mov_b32 v131, 0
    v_mov_b32 v132, 0
    v_mov_b32 v133, 0
    v_mov_b32 v134, 0
    v_mov_b32 v135, 0
    v_mov_b32 v136, 0
    v_mov_b32 v137, 0
    v_mov_b32 v138, 0
    v_mov_b32 v139, 0
    v_mov_b32 v140, 0
    v_mov_b32 v141, 0
    v_mov_b32 v142, 0
    v_mov_b32 v143, 0
    s_barrier
    v_add_u32 v220, s84, v216
    v_add_u32 v221, s84, v217
    v_add_u32 v222, s85, v218
    ds_read_b128 v[144:147], v220 offset:0
    ds_read_b128 v[148:151], v220 offset:512
    ds_read_b128 v[152:155], v220 offset:4096
    ds_read_b128 v[156:159], v220 offset:4608
    ds_read_b128 v[176:179], v222 offset:0
    ds_read_b128 v[180:183], v222 offset:2048
    ds_read_b128 v[184:187], v222 offset:4096
    ds_read_b128 v[188:191], v222 offset:6144
    ds_read_b128 v[192:195], v222 offset:8192
    v_add_u32 v223, s85, v219
    s_mov_b32 s86, 0
    s_mov_b32 s99, 4
    s_waitcnt lgkmcnt(4)
    v_mfma_f32_16x16x32_bf16 v[0:3], v[144:147], v[176:179], 0
    ds_read_b128 v[160:163], v221 offset:0
    v_mfma_f32_16x16x32_bf16 v[4:7], v[148:151], v[176:179], 0
    s_add_u32 s84, s84, 16384
    v_mfma_f32_16x16x32_bf16 v[8:11], v[152:155], v[176:179], 0
    ds_read_b128 v[164:167], v221 offset:512
    v_mfma_f32_16x16x32_bf16 v[12:15], v[156:159], v[176:179], 0
    s_and_b32 s84, s84, 0xffff
    s_waitcnt lgkmcnt(5)
    v_mfma_f32_16x16x32_bf16 v[16:19], v[144:147], v[180:183], 0
    ds_read_b128 v[168:171], v221 offset:4096
    v_mfma_f32_16x16x32_bf16 v[20:23], v[148:151], v[180:183], 0
    v_add_u32 v220, s84, v216
    v_mfma_f32_16x16x32_bf16 v[24:27], v[152:155], v[180:183], 0
    ds_read_b128 v[172:175], v221 offset:4608
    v_mfma_f32_16x16x32_bf16 v[28:31], v[156:159], v[180:183], 0
    s_add_u32 s85, s85, 20480
    s_waitcnt lgkmcnt(6)
    v_mfma_f32_16x16x32_bf16 v[32:35], v[144:147], v[184:187], 0
    ds_read_b128 v[196:199], v223 offset:0
    v_mfma_f32_16x16x32_bf16 v[36:39], v[148:151], v[184:187], 0
    s_cmp_eq_u32 s85, 81920
    v_mfma_f32_16x16x32_bf16 v[40:43], v[152:155], v[184:187], 0
    ds_read_b128 v[200:203], v223 offset:2048
    v_mfma_f32_16x16x32_bf16 v[44:47], v[156:159], v[184:187], 0
    s_cselect_b32 s85, 0, s85
    s_waitcnt lgkmcnt(7)
    v_mfma_f32_16x16x32_bf16 v[48:51], v[144:147], v[188:191], 0
    ds_read_b128 v[204:207], v223 offset:4096
    v_mfma_f32_16x16x32_bf16 v[52:55], v[148:151], v[188:191], 0
    v_add_u32 v222, s85, v218
    v_mfma_f32_16x16x32_bf16 v[56:59], v[152:155], v[188:191], 0
    ds_read_b128 v[208:211], v223 offset:6144
    v_mfma_f32_16x16x32_bf16 v[60:63], v[156:159], v[188:191], 0
    s_waitcnt lgkmcnt(8)
    v_mfma_f32_16x16x32_bf16 v[64:67], v[144:147], v[192:195], 0
    ds_read_b128 v[212:215], v223 offset:8192
    v_mfma_f32_16x16x32_bf16 v[68:71], v[148:151], v[192:195], 0
    v_mfma_f32_16x16x32_bf16 v[72:75], v[152:155], v[192:195], 0
    v_mfma_f32_16x16x32_bf16 v[76:79], v[156:159], v[192:195], 0
    s_branch LA1B_7
LA1A_6:
    s_waitcnt lgkmcnt(4)
    v_mfma_f32_16x16x32_bf16 v[0:3], v[144:147], v[176:179], v[0:3]
    ds_read_b128 v[160:163], v221 offset:0
    v_mfma_f32_16x16x32_bf16 v[4:7], v[148:151], v[176:179], v[4:7]
    s_add_u32 s84, s84, 16384
    v_mfma_f32_16x16x32_bf16 v[8:11], v[152:155], v[176:179], v[8:11]
    ds_read_b128 v[164:167], v221 offset:512
    v_mfma_f32_16x16x32_bf16 v[12:15], v[156:159], v[176:179], v[12:15]
    s_and_b32 s84, s84, 0xffff
    s_waitcnt lgkmcnt(5)
    v_mfma_f32_16x16x32_bf16 v[16:19], v[144:147], v[180:183], v[16:19]
    ds_read_b128 v[168:171], v221 offset:4096
    v_mfma_f32_16x16x32_bf16 v[20:23], v[148:151], v[180:183], v[20:23]
    v_add_u32 v220, s84, v216
    v_mfma_f32_16x16x32_bf16 v[24:27], v[152:155], v[180:183], v[24:27]
    ds_read_b128 v[172:175], v221 offset:4608
    v_mfma_f32_16x16x32_bf16 v[28:31], v[156:159], v[180:183], v[28:31]
    s_add_u32 s85, s85, 20480
    s_waitcnt lgkmcnt(6)
    v_mfma_f32_16x16x32_bf16 v[32:35], v[144:147], v[184:187], v[32:35]
    ds_read_b128 v[196:199], v223 offset:0
    v_mfma_f32_16x16x32_bf16 v[36:39], v[148:151], v[184:187], v[36:39]
    s_cmp_eq_u32 s85, 81920
    v_mfma_f32_16x16x32_bf16 v[40:43], v[152:155], v[184:187], v[40:43]
    ds_read_b128 v[200:203], v223 offset:2048
    v_mfma_f32_16x16x32_bf16 v[44:47], v[156:159], v[184:187], v[44:47]
    s_cselect_b32 s85, 0, s85
    s_waitcnt lgkmcnt(7)
    v_mfma_f32_16x16x32_bf16 v[48:51], v[144:147], v[188:191], v[48:51]
    ds_read_b128 v[204:207], v223 offset:4096
    v_mfma_f32_16x16x32_bf16 v[52:55], v[148:151], v[188:191], v[52:55]
    v_add_u32 v222, s85, v218
    v_mfma_f32_16x16x32_bf16 v[56:59], v[152:155], v[188:191], v[56:59]
    ds_read_b128 v[208:211], v223 offset:6144
    v_mfma_f32_16x16x32_bf16 v[60:63], v[156:159], v[188:191], v[60:63]
    s_waitcnt lgkmcnt(8)
    v_mfma_f32_16x16x32_bf16 v[64:67], v[144:147], v[192:195], v[64:67]
    ds_read_b128 v[212:215], v223 offset:8192
    v_mfma_f32_16x16x32_bf16 v[68:71], v[148:151], v[192:195], v[68:71]
    v_mfma_f32_16x16x32_bf16 v[72:75], v[152:155], v[192:195], v[72:75]
    v_mfma_f32_16x16x32_bf16 v[76:79], v[156:159], v[192:195], v[76:79]
LA1B_7:
    s_waitcnt lgkmcnt(4)
    v_mfma_f32_16x16x32_bf16 v[0:3], v[160:163], v[196:199], v[0:3]
    v_add_u32 v221, s84, v217
    v_mfma_f32_16x16x32_bf16 v[4:7], v[164:167], v[196:199], v[4:7]
    v_add_u32 v223, s85, v219
    v_mfma_f32_16x16x32_bf16 v[8:11], v[168:171], v[196:199], v[8:11]
    s_add_u32 s86, s86, 1
    v_mfma_f32_16x16x32_bf16 v[12:15], v[172:175], v[196:199], v[12:15]
    s_cmp_lt_u32 s86, s99
    s_waitcnt lgkmcnt(0)
    s_barrier
    v_mfma_f32_16x16x32_bf16 v[16:19], v[160:163], v[200:203], v[16:19]
    ds_read_b128 v[144:147], v220 offset:0
    v_mfma_f32_16x16x32_bf16 v[20:23], v[164:167], v[200:203], v[20:23]
    ds_read_b128 v[148:151], v220 offset:512
    v_mfma_f32_16x16x32_bf16 v[24:27], v[168:171], v[200:203], v[24:27]
    v_mfma_f32_16x16x32_bf16 v[28:31], v[172:175], v[200:203], v[28:31]
    ds_read_b128 v[152:155], v220 offset:4096
    v_mfma_f32_16x16x32_bf16 v[32:35], v[160:163], v[204:207], v[32:35]
    v_mfma_f32_16x16x32_bf16 v[36:39], v[164:167], v[204:207], v[36:39]
    ds_read_b128 v[156:159], v220 offset:4608
    v_mfma_f32_16x16x32_bf16 v[40:43], v[168:171], v[204:207], v[40:43]
    ds_read_b128 v[176:179], v222 offset:0
    v_mfma_f32_16x16x32_bf16 v[44:47], v[172:175], v[204:207], v[44:47]
    v_mfma_f32_16x16x32_bf16 v[48:51], v[160:163], v[208:211], v[48:51]
    ds_read_b128 v[180:183], v222 offset:2048
    v_mfma_f32_16x16x32_bf16 v[52:55], v[164:167], v[208:211], v[52:55]
    v_mfma_f32_16x16x32_bf16 v[56:59], v[168:171], v[208:211], v[56:59]
    ds_read_b128 v[184:187], v222 offset:4096
    v_mfma_f32_16x16x32_bf16 v[60:63], v[172:175], v[208:211], v[60:63]
    ds_read_b128 v[188:191], v222 offset:6144
    v_mfma_f32_16x16x32_bf16 v[64:67], v[160:163], v[212:215], v[64:67]
    v_mfma_f32_16x16x32_bf16 v[68:71], v[164:167], v[212:215], v[68:71]
    ds_read_b128 v[192:195], v222 offset:8192
    v_mfma_f32_16x16x32_bf16 v[72:75], v[168:171], v[212:215], v[72:75]
    v_mfma_f32_16x16x32_bf16 v[76:79], v[172:175], v[212:215], v[76:79]
    s_cbranch_scc1 LA1A_6
    s_cmp_eq_u32 s99, 6
    s_cbranch_scc1 LA1X_8
    s_mov_b32 s99, 6
    s_waitcnt vmcnt(0)
    buffer_store_dword v253, v254, s[60:63], 0 offen offset:48 sc1
    s_branch LA1A_6
LA1X_8:
    v_add_u32 v230, s84, v224
    v_add_u32 v231, s84, v225
    s_mov_b32 s86, 0
LFA_9:
    s_waitcnt lgkmcnt(4)
    v_mfma_f32_16x16x32_bf16 v[0:3], v[144:147], v[176:179], v[0:3]
    ds_read_b128 v[160:163], v221 offset:0
    v_mfma_f32_16x16x32_bf16 v[4:7], v[148:151], v[176:179], v[4:7]
    s_add_u32 s85, s85, 20480
    v_mfma_f32_16x16x32_bf16 v[8:11], v[152:155], v[176:179], v[8:11]
    ds_read_b128 v[164:167], v221 offset:512
    v_mfma_f32_16x16x32_bf16 v[12:15], v[156:159], v[176:179], v[12:15]
    s_cmp_eq_u32 s85, 81920
    s_waitcnt lgkmcnt(5)
    v_mfma_f32_16x16x32_bf16 v[16:19], v[144:147], v[180:183], v[16:19]
    ds_read_b128 v[168:171], v221 offset:4096
    v_mfma_f32_16x16x32_bf16 v[20:23], v[148:151], v[180:183], v[20:23]
    s_cselect_b32 s85, 0, s85
    v_mfma_f32_16x16x32_bf16 v[24:27], v[152:155], v[180:183], v[24:27]
    ds_read_b128 v[172:175], v221 offset:4608
    v_mfma_f32_16x16x32_bf16 v[28:31], v[156:159], v[180:183], v[28:31]
    v_add_u32 v232, s85, v226
    s_waitcnt lgkmcnt(6)
    v_mfma_f32_16x16x32_bf16 v[32:35], v[144:147], v[184:187], v[32:35]
    ds_read_b128 v[196:199], v223 offset:0
    v_mfma_f32_16x16x32_bf16 v[36:39], v[148:151], v[184:187], v[36:39]
    v_xor_b32 v233, 32, v232
    v_mfma_f32_16x16x32_bf16 v[40:43], v[152:155], v[184:187], v[40:43]
    ds_read_b128 v[200:203], v223 offset:2048
    v_mfma_f32_16x16x32_bf16 v[44:47], v[156:159], v[184:187], v[44:47]
    v_add_u32 v234, s85, v226
    s_waitcnt lgkmcnt(7)
    v_mfma_f32_16x16x32_bf16 v[48:51], v[144:147], v[188:191], v[48:51]
    ds_read_b128 v[204:207], v223 offset:4096
    v_mfma_f32_16x16x32_bf16 v[52:55], v[148:151], v[188:191], v[52:55]
    v_xor_b32 v235, 32, v234
    v_mfma_f32_16x16x32_bf16 v[56:59], v[152:155], v[188:191], v[56:59]
    ds_read_b128 v[208:211], v223 offset:6144
    v_mfma_f32_16x16x32_bf16 v[60:63], v[156:159], v[188:191], v[60:63]
    s_waitcnt lgkmcnt(8)
    v_mfma_f32_16x16x32_bf16 v[64:67], v[144:147], v[192:195], v[64:67]
    ds_read_b128 v[212:215], v223 offset:8192
    v_mfma_f32_16x16x32_bf16 v[68:71], v[148:151], v[192:195], v[68:71]
    v_mfma_f32_16x16x32_bf16 v[72:75], v[152:155], v[192:195], v[72:75]
    v_mfma_f32_16x16x32_bf16 v[76:79], v[156:159], v[192:195], v[76:79]
    s_waitcnt lgkmcnt(4)
    v_mfma_f32_16x16x32_bf16 v[0:3], v[160:163], v[196:199], v[0:3]
    v_mfma_f32_16x16x32_bf16 v[4:7], v[164:167], v[196:199], v[4:7]
    v_mfma_f32_16x16x32_bf16 v[8:11], v[168:171], v[196:199], v[8:11]
    v_mfma_f32_16x16x32_bf16 v[12:15], v[172:175], v[196:199], v[12:15]
    s_waitcnt lgkmcnt(0)
    s_barrier
    v_mfma_f32_16x16x32_bf16 v[16:19], v[160:163], v[200:203], v[16:19]
    ds_read_b128 v[144:147], v230 offset:0
    v_mfma_f32_16x16x32_bf16 v[20:23], v[164:167], v[200:203], v[20:23]
    ds_read_b128 v[148:151], v230 offset:2048
    v_mfma_f32_16x16x32_bf16 v[24:27], v[168:171], v[200:203], v[24:27]
    ds_read_b128 v[152:155], v230 offset:4096
    v_mfma_f32_16x16x32_bf16 v[28:31], v[172:175], v[200:203], v[28:31]
    ds_read_b128 v[156:159], v230 offset:6144
    v_mfma_f32_16x16x32_bf16 v[32:35], v[160:163], v[204:207], v[32:35]
    v_mfma_f32_16x16x32_bf16 v[36:39], v[164:167], v[204:207], v[36:39]
    ds_read_b64_tr_b16 v[176:177], v232 offset:0
    v_mfma_f32_16x16x32_bf16 v[40:43], v[168:171], v[204:207], v[40:43]
    ds_read_b64_tr_b16 v[178:179], v232 offset:512
    v_mfma_f32_16x16x32_bf16 v[44:47], v[172:175], v[204:207], v[44:47]
    ds_read_b64_tr_b16 v[180:181], v233 offset:0
    v_mfma_f32_16x16x32_bf16 v[48:51], v[160:163], v[208:211], v[48:51]
    ds_read_b64_tr_b16 v[182:183], v233 offset:512
    v_mfma_f32_16x16x32_bf16 v[52:55], v[164:167], v[208:211], v[52:55]
    v_mfma_f32_16x16x32_bf16 v[56:59], v[168:171], v[208:211], v[56:59]
    ds_read_b64_tr_b16 v[184:185], v232 offset:8192
    v_mfma_f32_16x16x32_bf16 v[60:63], v[172:175], v[208:211], v[60:63]
    ds_read_b64_tr_b16 v[186:187], v232 offset:8704
    v_mfma_f32_16x16x32_bf16 v[64:67], v[160:163], v[212:215], v[64:67]
    ds_read_b64_tr_b16 v[188:189], v233 offset:8192
    v_mfma_f32_16x16x32_bf16 v[68:71], v[164:167], v[212:215], v[68:71]
    ds_read_b64_tr_b16 v[190:191], v233 offset:8704
    v_mfma_f32_16x16x32_bf16 v[72:75], v[168:171], v[212:215], v[72:75]
    v_mfma_f32_16x16x32_bf16 v[76:79], v[172:175], v[212:215], v[76:79]
    s_waitcnt lgkmcnt(6)
    v_mfma_f32_16x16x32_bf16 v[80:83], v[176:179], v[144:147], v[80:83]
    ds_read_b128 v[160:163], v231 offset:0
    s_add_u32 s84, s84, 16384
    v_mfma_f32_16x16x32_bf16 v[84:87], v[176:179], v[148:151], v[84:87]
    ds_read_b128 v[164:167], v231 offset:2048
    s_and_b32 s84, s84, 0xffff
    v_mfma_f32_16x16x32_bf16 v[88:91], v[176:179], v[152:155], v[88:91]
    ds_read_b128 v[168:171], v231 offset:4096
    v_add_u32 v220, s84, v216
    v_mfma_f32_16x16x32_bf16 v[92:95], v[176:179], v[156:159], v[92:95]
    ds_read_b128 v[172:175], v231 offset:6144
    s_add_u32 s85, s85, 20480
    s_waitcnt lgkmcnt(8)
    v_mfma_f32_16x16x32_bf16 v[96:99], v[180:183], v[144:147], v[96:99]
    s_cmp_eq_u32 s85, 81920
    v_mfma_f32_16x16x32_bf16 v[100:103], v[180:183], v[148:151], v[100:103]
    ds_read_b64_tr_b16 v[196:197], v234 offset:4096
    v_mfma_f32_16x16x32_bf16 v[104:107], v[180:183], v[152:155], v[104:107]
    ds_read_b64_tr_b16 v[198:199], v234 offset:4608
    v_mfma_f32_16x16x32_bf16 v[108:111], v[180:183], v[156:159], v[108:111]
    ds_read_b64_tr_b16 v[200:201], v235 offset:4096
    s_waitcnt lgkmcnt(9)
    v_mfma_f32_16x16x32_bf16 v[112:115], v[184:187], v[144:147], v[112:115]
    ds_read_b64_tr_b16 v[202:203], v235 offset:4608
    v_mfma_f32_16x16x32_bf16 v[116:119], v[184:187], v[148:151], v[116:119]
    s_cselect_b32 s85, 0, s85
    v_mfma_f32_16x16x32_bf16 v[120:123], v[184:187], v[152:155], v[120:123]
    ds_read_b64_tr_b16 v[204:205], v234 offset:12288
    v_mfma_f32_16x16x32_bf16 v[124:127], v[184:187], v[156:159], v[124:127]
    ds_read_b64_tr_b16 v[206:207], v234 offset:12800
    s_waitcnt lgkmcnt(10)
    v_mfma_f32_16x16x32_bf16 v[128:131], v[188:191], v[144:147], v[128:131]
    ds_read_b64_tr_b16 v[208:209], v235 offset:12288
    v_mfma_f32_16x16x32_bf16 v[132:135], v[188:191], v[148:151], v[132:135]
    ds_read_b64_tr_b16 v[210:211], v235 offset:12800
    v_mfma_f32_16x16x32_bf16 v[136:139], v[188:191], v[152:155], v[136:139]
    v_add_u32 v222, s85, v218
    v_mfma_f32_16x16x32_bf16 v[140:143], v[188:191], v[156:159], v[140:143]
    v_add_u32 v223, s85, v219
    s_waitcnt lgkmcnt(6)
    v_mfma_f32_16x16x32_bf16 v[80:83], v[196:199], v[160:163], v[80:83]
    v_add_u32 v221, s84, v217
    v_mfma_f32_16x16x32_bf16 v[84:87], v[196:199], v[164:167], v[84:87]
    v_add_u32 v230, s84, v224
    v_mfma_f32_16x16x32_bf16 v[88:91], v[196:199], v[168:171], v[88:91]
    v_add_u32 v231, s84, v225
    v_mfma_f32_16x16x32_bf16 v[92:95], v[196:199], v[172:175], v[92:95]
    s_add_u32 s86, s86, 1
    s_waitcnt lgkmcnt(0)
    s_barrier
    v_mfma_f32_16x16x32_bf16 v[96:99], v[200:203], v[160:163], v[96:99]
    ds_read_b128 v[144:147], v220 offset:0
    v_mfma_f32_16x16x32_bf16 v[100:103], v[200:203], v[164:167], v[100:103]
    ds_read_b128 v[148:151], v220 offset:512
    v_mfma_f32_16x16x32_bf16 v[104:107], v[200:203], v[168:171], v[104:107]
    ds_read_b128 v[152:155], v220 offset:4096
    v_mfma_f32_16x16x32_bf16 v[108:111], v[200:203], v[172:175], v[108:111]
    ds_read_b128 v[156:159], v220 offset:4608
    v_mfma_f32_16x16x32_bf16 v[112:115], v[204:207], v[160:163], v[112:115]
    ds_read_b128 v[176:179], v222 offset:0
    v_mfma_f32_16x16x32_bf16 v[116:119], v[204:207], v[164:167], v[116:119]
    s_cmp_lt_u32 s86, 4
    v_mfma_f32_16x16x32_bf16 v[120:123], v[204:207], v[168:171], v[120:123]
    ds_read_b128 v[180:183], v222 offset:2048
    v_mfma_f32_16x16x32_bf16 v[124:127], v[204:207], v[172:175], v[124:127]
    ds_read_b128 v[184:187], v222 offset:4096
    v_mfma_f32_16x16x32_bf16 v[128:131], v[208:211], v[160:163], v[128:131]
    ds_read_b128 v[188:191], v222 offset:6144
    v_mfma_f32_16x16x32_bf16 v[132:135], v[208:211], v[164:167], v[132:135]
    ds_read_b128 v[192:195], v222 offset:8192
    v_mfma_f32_16x16x32_bf16 v[136:139], v[208:211], v[168:171], v[136:139]
    v_mfma_f32_16x16x32_bf16 v[140:143], v[208:211], v[172:175], v[140:143]
    s_cbranch_scc1 LFA_9
    s_nop 7
    s_waitcnt lgkmcnt(0)
    s_lshl_b32 s78, s98, 6
    s_lshl_b32 s79, s73, 2
    s_add_u32 s78, s78, s79
    s_lshl_b32 s79, s87, 1
    s_add_u32 s78, s78, s79
    s_mul_i32 s78, s78, 10
    s_mul_i32 s79, s88, 5
    s_add_u32 s78, s78, s79
    s_lshl_b32 s94, s78, 10
    s_add_u32 s94, s94, 0
    s_add_u32 s95, s94, 4096
    s_add_u32 s96, s94, 10240
    s_add_u32 s97, s94, 14336
    v_lshlrev_b32 v252, 4, v244
    s_nop 4
    v_cvt_pk_bf16_f32 v144, v0, v1
    v_cvt_pk_bf16_f32 v145, v2, v3
    v_cvt_pk_bf16_f32 v146, v4, v5
    v_cvt_pk_bf16_f32 v147, v6, v7
    v_xor_b32 v144, s93, v144
    v_xor_b32 v145, s93, v145
    v_xor_b32 v146, s93, v146
    v_xor_b32 v147, s93, v147
    buffer_store_dwordx4 v[144:147], v252, s[60:63], s94 offen sc1
    v_cvt_pk_bf16_f32 v148, v16, v17
    v_cvt_pk_bf16_f32 v149, v18, v19
    v_cvt_pk_bf16_f32 v150, v20, v21
    v_cvt_pk_bf16_f32 v151, v22, v23
    v_xor_b32 v148, s93, v148
    v_xor_b32 v149, s93, v149
    v_xor_b32 v150, s93, v150
    v_xor_b32 v151, s93, v151
    buffer_store_dwordx4 v[148:151], v252, s[60:63], s94 offen offset:1024 sc1
    v_cvt_pk_bf16_f32 v152, v32, v33
    v_cvt_pk_bf16_f32 v153, v34, v35
    v_cvt_pk_bf16_f32 v154, v36, v37
    v_cvt_pk_bf16_f32 v155, v38, v39
    v_xor_b32 v152, s93, v152
    v_xor_b32 v153, s93, v153
    v_xor_b32 v154, s93, v154
    v_xor_b32 v155, s93, v155
    buffer_store_dwordx4 v[152:155], v252, s[60:63], s94 offen offset:2048 sc1
    v_cvt_pk_bf16_f32 v156, v48, v49
    v_cvt_pk_bf16_f32 v157, v50, v51
    v_cvt_pk_bf16_f32 v158, v52, v53
    v_cvt_pk_bf16_f32 v159, v54, v55
    v_xor_b32 v156, s93, v156
    v_xor_b32 v157, s93, v157
    v_xor_b32 v158, s93, v158
    v_xor_b32 v159, s93, v159
    buffer_store_dwordx4 v[156:159], v252, s[60:63], s94 offen offset:3072 sc1
    v_cvt_pk_bf16_f32 v160, v64, v65
    v_cvt_pk_bf16_f32 v161, v66, v67
    v_cvt_pk_bf16_f32 v162, v68, v69
    v_cvt_pk_bf16_f32 v163, v70, v71
    v_xor_b32 v160, s93, v160
    v_xor_b32 v161, s93, v161
    v_xor_b32 v162, s93, v162
    v_xor_b32 v163, s93, v163
    buffer_store_dwordx4 v[160:163], v252, s[60:63], s95 offen sc1
    v_cvt_pk_bf16_f32 v164, v8, v9
    v_cvt_pk_bf16_f32 v165, v10, v11
    v_cvt_pk_bf16_f32 v166, v12, v13
    v_cvt_pk_bf16_f32 v167, v14, v15
    v_xor_b32 v164, s93, v164
    v_xor_b32 v165, s93, v165
    v_xor_b32 v166, s93, v166
    v_xor_b32 v167, s93, v167
    buffer_store_dwordx4 v[164:167], v252, s[60:63], s96 offen sc1
    v_cvt_pk_bf16_f32 v168, v24, v25
    v_cvt_pk_bf16_f32 v169, v26, v27
    v_cvt_pk_bf16_f32 v170, v28, v29
    v_cvt_pk_bf16_f32 v171, v30, v31
    v_xor_b32 v168, s93, v168
    v_xor_b32 v169, s93, v169
    v_xor_b32 v170, s93, v170
    v_xor_b32 v171, s93, v171
    buffer_store_dwordx4 v[168:171], v252, s[60:63], s96 offen offset:1024 sc1
    v_cvt_pk_bf16_f32 v172, v40, v41
    v_cvt_pk_bf16_f32 v173, v42, v43
    v_cvt_pk_bf16_f32 v174, v44, v45
    v_cvt_pk_bf16_f32 v175, v46, v47
    v_xor_b32 v172, s93, v172
    v_xor_b32 v173, s93, v173
    v_xor_b32 v174, s93, v174
    v_xor_b32 v175, s93, v175
    buffer_store_dwordx4 v[172:175], v252, s[60:63], s96 offen offset:2048 sc1
    v_cvt_pk_bf16_f32 v176, v56, v57
    v_cvt_pk_bf16_f32 v177, v58, v59
    v_cvt_pk_bf16_f32 v178, v60, v61
    v_cvt_pk_bf16_f32 v179, v62, v63
    v_xor_b32 v176, s93, v176
    v_xor_b32 v177, s93, v177
    v_xor_b32 v178, s93, v178
    v_xor_b32 v179, s93, v179
    buffer_store_dwordx4 v[176:179], v252, s[60:63], s96 offen offset:3072 sc1
    v_cvt_pk_bf16_f32 v180, v72, v73
    v_cvt_pk_bf16_f32 v181, v74, v75
    v_cvt_pk_bf16_f32 v182, v76, v77
    v_cvt_pk_bf16_f32 v183, v78, v79
    v_xor_b32 v180, s93, v180
    v_xor_b32 v181, s93, v181
    v_xor_b32 v182, s93, v182
    v_xor_b32 v183, s93, v183
    buffer_store_dwordx4 v[180:183], v252, s[60:63], s97 offen sc1
    s_barrier
    v_add_u32 v230, s84, v224
    v_add_u32 v231, s84, v225
    v_add_u32 v232, s85, v226
    v_xor_b32 v233, 32, v232
    ds_read_b128 v[144:147], v230 offset:0
    ds_read_b128 v[148:151], v230 offset:2048
    ds_read_b128 v[152:155], v230 offset:4096
    ds_read_b128 v[156:159], v230 offset:6144
    ds_read_b64_tr_b16 v[176:177], v232 offset:0
    ds_read_b64_tr_b16 v[178:179], v232 offset:512
    ds_read_b64_tr_b16 v[180:181], v233 offset:0
    ds_read_b64_tr_b16 v[182:183], v233 offset:512
    ds_read_b64_tr_b16 v[184:185], v232 offset:8192
    ds_read_b64_tr_b16 v[186:187], v232 offset:8704
    ds_read_b64_tr_b16 v[188:189], v233 offset:8192
    ds_read_b64_tr_b16 v[190:191], v233 offset:8704
    v_add_u32 v234, s85, v226
    v_xor_b32 v235, 32, v234
    s_mov_b32 s86, 0
    s_mov_b32 s99, 2
LB1yA_12:
    s_waitcnt lgkmcnt(6)
    v_mfma_f32_16x16x32_bf16 v[80:83], v[176:179], v[144:147], v[80:83]
    ds_read_b128 v[160:163], v231 offset:0
    s_add_u32 s84, s84, 16384
    v_mfma_f32_16x16x32_bf16 v[84:87], v[176:179], v[148:151], v[84:87]
    ds_read_b128 v[164:167], v231 offset:2048
    s_and_b32 s84, s84, 0xffff
    v_mfma_f32_16x16x32_bf16 v[88:91], v[176:179], v[152:155], v[88:91]
    ds_read_b128 v[168:171], v231 offset:4096
    v_add_u32 v230, s84, v224
    v_mfma_f32_16x16x32_bf16 v[92:95], v[176:179], v[156:159], v[92:95]
    ds_read_b128 v[172:175], v231 offset:6144
    s_add_u32 s85, s85, 20480
    s_waitcnt lgkmcnt(8)
    v_mfma_f32_16x16x32_bf16 v[96:99], v[180:183], v[144:147], v[96:99]
    s_cmp_eq_u32 s85, 81920
    v_mfma_f32_16x16x32_bf16 v[100:103], v[180:183], v[148:151], v[100:103]
    ds_read_b64_tr_b16 v[196:197], v234 offset:4096
    v_mfma_f32_16x16x32_bf16 v[104:107], v[180:183], v[152:155], v[104:107]
    ds_read_b64_tr_b16 v[198:199], v234 offset:4608
    v_mfma_f32_16x16x32_bf16 v[108:111], v[180:183], v[156:159], v[108:111]
    ds_read_b64_tr_b16 v[200:201], v235 offset:4096
    s_waitcnt lgkmcnt(9)
    v_mfma_f32_16x16x32_bf16 v[112:115], v[184:187], v[144:147], v[112:115]
    ds_read_b64_tr_b16 v[202:203], v235 offset:4608
    v_mfma_f32_16x16x32_bf16 v[116:119], v[184:187], v[148:151], v[116:119]
    s_cselect_b32 s85, 0, s85
    v_mfma_f32_16x16x32_bf16 v[120:123], v[184:187], v[152:155], v[120:123]
    ds_read_b64_tr_b16 v[204:205], v234 offset:12288
    v_mfma_f32_16x16x32_bf16 v[124:127], v[184:187], v[156:159], v[124:127]
    ds_read_b64_tr_b16 v[206:207], v234 offset:12800
    s_waitcnt lgkmcnt(10)
    v_mfma_f32_16x16x32_bf16 v[128:131], v[188:191], v[144:147], v[128:131]
    ds_read_b64_tr_b16 v[208:209], v235 offset:12288
    v_mfma_f32_16x16x32_bf16 v[132:135], v[188:191], v[148:151], v[132:135]
    ds_read_b64_tr_b16 v[210:211], v235 offset:12800
    v_mfma_f32_16x16x32_bf16 v[136:139], v[188:191], v[152:155], v[136:139]
    v_add_u32 v232, s85, v226
    v_mfma_f32_16x16x32_bf16 v[140:143], v[188:191], v[156:159], v[140:143]
    v_xor_b32 v233, 32, v232
LB1yB_13:
    s_waitcnt lgkmcnt(6)
    v_mfma_f32_16x16x32_bf16 v[80:83], v[196:199], v[160:163], v[80:83]
    v_add_u32 v231, s84, v225
    v_mfma_f32_16x16x32_bf16 v[84:87], v[196:199], v[164:167], v[84:87]
    v_add_u32 v234, s85, v226
    v_mfma_f32_16x16x32_bf16 v[88:91], v[196:199], v[168:171], v[88:91]
    v_xor_b32 v235, 32, v234
    v_mfma_f32_16x16x32_bf16 v[92:95], v[196:199], v[172:175], v[92:95]
    s_add_u32 s86, s86, 1
    s_waitcnt lgkmcnt(0)
    s_barrier
    v_mfma_f32_16x16x32_bf16 v[96:99], v[200:203], v[160:163], v[96:99]
    ds_read_b128 v[144:147], v230 offset:0
    ds_read_b128 v[148:151], v230 offset:2048
    v_mfma_f32_16x16x32_bf16 v[100:103], v[200:203], v[164:167], v[100:103]
    ds_read_b128 v[152:155], v230 offset:4096
    v_mfma_f32_16x16x32_bf16 v[104:107], v[200:203], v[168:171], v[104:107]
    ds_read_b128 v[156:159], v230 offset:6144
    v_mfma_f32_16x16x32_bf16 v[108:111], v[200:203], v[172:175], v[108:111]
    ds_read_b64_tr_b16 v[176:177], v232 offset:0
    v_mfma_f32_16x16x32_bf16 v[112:115], v[204:207], v[160:163], v[112:115]
    ds_read_b64_tr_b16 v[178:179], v232 offset:512
    v_mfma_f32_16x16x32_bf16 v[116:119], v[204:207], v[164:167], v[116:119]
    ds_read_b64_tr_b16 v[180:181], v233 offset:0
    v_mfma_f32_16x16x32_bf16 v[120:123], v[204:207], v[168:171], v[120:123]
    ds_read_b64_tr_b16 v[182:183], v233 offset:512
    v_mfma_f32_16x16x32_bf16 v[124:127], v[204:207], v[172:175], v[124:127]
    ds_read_b64_tr_b16 v[184:185], v232 offset:8192
    v_mfma_f32_16x16x32_bf16 v[128:131], v[208:211], v[160:163], v[128:131]
    ds_read_b64_tr_b16 v[186:187], v232 offset:8704
    v_mfma_f32_16x16x32_bf16 v[132:135], v[208:211], v[164:167], v[132:135]
    ds_read_b64_tr_b16 v[188:189], v233 offset:8192
    v_mfma_f32_16x16x32_bf16 v[136:139], v[208:211], v[168:171], v[136:139]
    ds_read_b64_tr_b16 v[190:191], v233 offset:8704
    v_mfma_f32_16x16x32_bf16 v[140:143], v[208:211], v[172:175], v[140:143]
    s_cmp_lt_u32 s86, s99
    s_cbranch_scc1 LB1yA_12
    s_cmp_eq_u32 s99, 6
    s_cbranch_scc1 LB1yX_14
    s_mov_b32 s99, 6
    s_waitcnt vmcnt(0)
    buffer_store_dword v253, v254, s[60:63], 0 offen offset:0 sc1
    s_branch LB1yA_12
LB1yX_14:
    s_nop 7
    s_waitcnt lgkmcnt(0)
    v_and_b32 v245, 15, v244
    v_lshlrev_b32 v245, 2, v245
    s_lshl_b32 s78, s87, 8
    v_add_u32 v245, s78, v245
    v_add_u32 v245, 147456, v245
    ds_read_b32 v240, v245 offset:2048
    ds_read_b32 v241, v245 offset:2112
    ds_read_b32 v242, v245 offset:2176
    ds_read_b32 v243, v245 offset:2240
    s_lshl_b32 s78, s72, 6
    s_xor_b32 s79, s78, 0
    v_add_u32 v246, s79, v245
    ds_read_b32 v236, v246 offset:2560
    s_xor_b32 s79, s78, 64
    v_add_u32 v246, s79, v245
    ds_read_b32 v237, v246 offset:2560
    s_xor_b32 s79, s78, 128
    v_add_u32 v246, s79, v245
    ds_read_b32 v238, v246 offset:2560
    s_xor_b32 s79, s78, 192
    v_add_u32 v246, s79, v245
    ds_read_b32 v239, v246 offset:2560
    s_mul_i32 s78, s72, 6
    s_add_u32 s78, s78, s74
    s_add_u32 s78, s78, 2
    s_lshl_b32 s78, s78, 1
    s_add_u32 s78, s78, s88
    s_mul_i32 s79, s73, 48
    s_add_u32 s78, s78, s79
    s_lshl_b32 s78, s78, 3
    s_lshl_b32 s79, s87, 2
    s_add_u32 s78, s78, s79
    s_lshl_b32 s94, s78, 10
    s_add_u32 s94, s94, 5242880
    s_add_u32 s95, s94, 8192
    v_lshlrev_b32 v252, 4, v244
    s_mov_b32 s83, 0xbfb8aa3b
    s_waitcnt lgkmcnt(0)
    v_mul_f32 v80, s83, v80
    v_mul_f32 v81, s83, v81
    v_mul_f32 v82, s83, v82
    v_mul_f32 v83, s83, v83
    v_mul_f32 v96, s83, v96
    v_mul_f32 v97, s83, v97
    v_mul_f32 v98, s83, v98
    v_mul_f32 v99, s83, v99
    v_exp_f32 v80, v80
    v_exp_f32 v81, v81
    v_exp_f32 v82, v82
    v_exp_f32 v83, v83
    v_exp_f32 v96, v96
    v_exp_f32 v97, v97
    v_exp_f32 v98, v98
    v_exp_f32 v99, v99
    v_fma_f32 v80, v80, v240, v240
    v_fma_f32 v81, v81, v240, v240
    v_fma_f32 v82, v82, v240, v240
    v_fma_f32 v83, v83, v240, v240
    v_fma_f32 v96, v96, v240, v240
    v_fma_f32 v97, v97, v240, v240
    v_fma_f32 v98, v98, v240, v240
    v_fma_f32 v99, v99, v240, v240
    v_rcp_f32 v80, v80
    v_rcp_f32 v81, v81
    v_rcp_f32 v82, v82
    v_rcp_f32 v83, v83
    v_rcp_f32 v96, v96
    v_rcp_f32 v97, v97
    v_rcp_f32 v98, v98
    v_rcp_f32 v99, v99
    v_mul_f32 v80, v80, v112
    v_mul_f32 v81, v81, v113
    v_mul_f32 v82, v82, v114
    v_mul_f32 v83, v83, v115
    v_mul_f32 v96, v96, v128
    v_mul_f32 v97, v97, v129
    v_mul_f32 v98, v98, v130
    v_mul_f32 v99, v99, v131
    v_cvt_pk_bf16_f32 v196, v80, v81
    v_cvt_pk_bf16_f32 v197, v82, v83
    v_cvt_pk_bf16_f32 v198, v96, v97
    v_cvt_pk_bf16_f32 v199, v98, v99
    buffer_store_dwordx4 v[196:199], v252, s[60:63], s94 offen sc1
    v_mul_f32 v84, s83, v84
    v_mul_f32 v85, s83, v85
    v_mul_f32 v86, s83, v86
    v_mul_f32 v87, s83, v87
    v_mul_f32 v100, s83, v100
    v_mul_f32 v101, s83, v101
    v_mul_f32 v102, s83, v102
    v_mul_f32 v103, s83, v103
    v_exp_f32 v84, v84
    v_exp_f32 v85, v85
    v_exp_f32 v86, v86
    v_exp_f32 v87, v87
    v_exp_f32 v100, v100
    v_exp_f32 v101, v101
    v_exp_f32 v102, v102
    v_exp_f32 v103, v103
    v_fma_f32 v84, v84, v241, v241
    v_fma_f32 v85, v85, v241, v241
    v_fma_f32 v86, v86, v241, v241
    v_fma_f32 v87, v87, v241, v241
    v_fma_f32 v100, v100, v241, v241
    v_fma_f32 v101, v101, v241, v241
    v_fma_f32 v102, v102, v241, v241
    v_fma_f32 v103, v103, v241, v241
    v_rcp_f32 v84, v84
    v_rcp_f32 v85, v85
    v_rcp_f32 v86, v86
    v_rcp_f32 v87, v87
    v_rcp_f32 v100, v100
    v_rcp_f32 v101, v101
    v_rcp_f32 v102, v102
    v_rcp_f32 v103, v103
    v_mul_f32 v84, v84, v116
    v_mul_f32 v85, v85, v117
    v_mul_f32 v86, v86, v118
    v_mul_f32 v87, v87, v119
    v_mul_f32 v100, v100, v132
    v_mul_f32 v101, v101, v133
    v_mul_f32 v102, v102, v134
    v_mul_f32 v103, v103, v135
    v_cvt_pk_bf16_f32 v200, v84, v85
    v_cvt_pk_bf16_f32 v201, v86, v87
    v_cvt_pk_bf16_f32 v202, v100, v101
    v_cvt_pk_bf16_f32 v203, v102, v103
    buffer_store_dwordx4 v[200:203], v252, s[60:63], s94 offen offset:1024 sc1
    v_mul_f32 v88, s83, v88
    v_mul_f32 v89, s83, v89
    v_mul_f32 v90, s83, v90
    v_mul_f32 v91, s83, v91
    v_mul_f32 v104, s83, v104
    v_mul_f32 v105, s83, v105
    v_mul_f32 v106, s83, v106
    v_mul_f32 v107, s83, v107
    v_exp_f32 v88, v88
    v_exp_f32 v89, v89
    v_exp_f32 v90, v90
    v_exp_f32 v91, v91
    v_exp_f32 v104, v104
    v_exp_f32 v105, v105
    v_exp_f32 v106, v106
    v_exp_f32 v107, v107
    v_fma_f32 v88, v88, v242, v242
    v_fma_f32 v89, v89, v242, v242
    v_fma_f32 v90, v90, v242, v242
    v_fma_f32 v91, v91, v242, v242
    v_fma_f32 v104, v104, v242, v242
    v_fma_f32 v105, v105, v242, v242
    v_fma_f32 v106, v106, v242, v242
    v_fma_f32 v107, v107, v242, v242
    v_rcp_f32 v88, v88
    v_rcp_f32 v89, v89
    v_rcp_f32 v90, v90
    v_rcp_f32 v91, v91
    v_rcp_f32 v104, v104
    v_rcp_f32 v105, v105
    v_rcp_f32 v106, v106
    v_rcp_f32 v107, v107
    v_mul_f32 v88, v88, v120
    v_mul_f32 v89, v89, v121
    v_mul_f32 v90, v90, v122
    v_mul_f32 v91, v91, v123
    v_mul_f32 v104, v104, v136
    v_mul_f32 v105, v105, v137
    v_mul_f32 v106, v106, v138
    v_mul_f32 v107, v107, v139
    v_cvt_pk_bf16_f32 v204, v88, v89
    v_cvt_pk_bf16_f32 v205, v90, v91
    v_cvt_pk_bf16_f32 v206, v104, v105
    v_cvt_pk_bf16_f32 v207, v106, v107
    buffer_store_dwordx4 v[204:207], v252, s[60:63], s94 offen offset:2048 sc1
    v_mul_f32 v92, s83, v92
    v_mul_f32 v93, s83, v93
    v_mul_f32 v94, s83, v94
    v_mul_f32 v95, s83, v95
    v_mul_f32 v108, s83, v108
    v_mul_f32 v109, s83, v109
    v_mul_f32 v110, s83, v110
    v_mul_f32 v111, s83, v111
    v_exp_f32 v92, v92
    v_exp_f32 v93, v93
    v_exp_f32 v94, v94
    v_exp_f32 v95, v95
    v_exp_f32 v108, v108
    v_exp_f32 v109, v109
    v_exp_f32 v110, v110
    v_exp_f32 v111, v111
    v_fma_f32 v92, v92, v243, v243
    v_fma_f32 v93, v93, v243, v243
    v_fma_f32 v94, v94, v243, v243
    v_fma_f32 v95, v95, v243, v243
    v_fma_f32 v108, v108, v243, v243
    v_fma_f32 v109, v109, v243, v243
    v_fma_f32 v110, v110, v243, v243
    v_fma_f32 v111, v111, v243, v243
    v_rcp_f32 v92, v92
    v_rcp_f32 v93, v93
    v_rcp_f32 v94, v94
    v_rcp_f32 v95, v95
    v_rcp_f32 v108, v108
    v_rcp_f32 v109, v109
    v_rcp_f32 v110, v110
    v_rcp_f32 v111, v111
    v_mul_f32 v92, v92, v124
    v_mul_f32 v93, v93, v125
    v_mul_f32 v94, v94, v126
    v_mul_f32 v95, v95, v127
    v_mul_f32 v108, v108, v140
    v_mul_f32 v109, v109, v141
    v_mul_f32 v110, v110, v142
    v_mul_f32 v111, v111, v143
    v_cvt_pk_bf16_f32 v208, v92, v93
    v_cvt_pk_bf16_f32 v209, v94, v95
    v_cvt_pk_bf16_f32 v210, v108, v109
    v_cvt_pk_bf16_f32 v211, v110, v111
    buffer_store_dwordx4 v[208:211], v252, s[60:63], s94 offen offset:3072 sc1
L_cons_p2:
    v_and_b32 v245, 15, v244
    v_lshrrev_b32 v246, 4, v244
    v_lshrrev_b32 v247, 1, v245
    v_xor_b32 v247, v247, v246
    v_lshlrev_b32 v247, 4, v247
    v_lshl_add_u32 v247, v245, 7, v247
    s_lshl_b32 s78, s87, 13
    v_add_u32 v224, s78, v247
    v_xor_b32 v225, 64, v224
    s_mul_i32 s78, s88, 5120
    s_add_u32 s78, s78, 65536
    v_lshlrev_b32 v247, 4, v244
    v_add_u32 v226, s78, v247
    s_barrier
    v_add_u32 v230, s84, v224
    v_add_u32 v231, s84, v225
    v_add_u32 v232, s85, v226
    ds_read_b128 v[128:131], v230 offset:0
    ds_read_b128 v[132:135], v230 offset:2048
    ds_read_b128 v[136:139], v230 offset:4096
    ds_read_b128 v[140:143], v230 offset:6144
    ds_read_b128 v[160:163], v232 offset:0
    ds_read_b128 v[164:167], v232 offset:1024
    ds_read_b128 v[168:171], v232 offset:2048
    ds_read_b128 v[172:175], v232 offset:3072
    ds_read_b128 v[176:179], v232 offset:4096
    v_add_u32 v240, s85, v226
    s_mov_b32 s86, 0
    s_mov_b32 s99, 2
    s_waitcnt lgkmcnt(4)
    v_mfma_f32_16x16x32_bf16 v[0:3], v[160:163], v[128:131], 0
    ds_read_b128 v[144:147], v231 offset:0
    v_mfma_f32_16x16x32_bf16 v[4:7], v[160:163], v[132:135], 0
    s_add_u32 s84, s84, 16384
    v_mfma_f32_16x16x32_bf16 v[8:11], v[160:163], v[136:139], 0
    ds_read_b128 v[148:151], v231 offset:2048
    v_mfma_f32_16x16x32_bf16 v[12:15], v[160:163], v[140:143], 0
    s_and_b32 s84, s84, 0xffff
    s_waitcnt lgkmcnt(5)
    v_mfma_f32_16x16x32_bf16 v[16:19], v[164:167], v[128:131], 0
    ds_read_b128 v[152:155], v231 offset:4096
    v_mfma_f32_16x16x32_bf16 v[20:23], v[164:167], v[132:135], 0
    v_add_u32 v230, s84, v224
    v_mfma_f32_16x16x32_bf16 v[24:27], v[164:167], v[136:139], 0
    ds_read_b128 v[156:159], v231 offset:6144
    v_mfma_f32_16x16x32_bf16 v[28:31], v[164:167], v[140:143], 0
    s_add_u32 s85, s85, 20480
    s_waitcnt lgkmcnt(6)
    v_mfma_f32_16x16x32_bf16 v[32:35], v[168:171], v[128:131], 0
    ds_read_b128 v[192:195], v240 offset:10240
    v_mfma_f32_16x16x32_bf16 v[36:39], v[168:171], v[132:135], 0
    s_cmp_eq_u32 s85, 81920
    v_mfma_f32_16x16x32_bf16 v[40:43], v[168:171], v[136:139], 0
    ds_read_b128 v[196:199], v240 offset:11264
    v_mfma_f32_16x16x32_bf16 v[44:47], v[168:171], v[140:143], 0
    s_cselect_b32 s85, 0, s85
    s_waitcnt lgkmcnt(7)
    v_mfma_f32_16x16x32_bf16 v[48:51], v[172:175], v[128:131], 0
    ds_read_b128 v[200:203], v240 offset:12288
    v_mfma_f32_16x16x32_bf16 v[52:55], v[172:175], v[132:135], 0
    v_add_u32 v232, s85, v226
    v_mfma_f32_16x16x32_bf16 v[56:59], v[172:175], v[136:139], 0
    ds_read_b128 v[204:207], v240 offset:13312
    v_mfma_f32_16x16x32_bf16 v[60:63], v[172:175], v[140:143], 0
    s_waitcnt lgkmcnt(8)
    v_mfma_f32_16x16x32_bf16 v[64:67], v[176:179], v[128:131], 0
    ds_read_b128 v[208:211], v240 offset:14336
    v_mfma_f32_16x16x32_bf16 v[68:71], v[176:179], v[132:135], 0
    v_mfma_f32_16x16x32_bf16 v[72:75], v[176:179], v[136:139], 0
    v_mfma_f32_16x16x32_bf16 v[76:79], v[176:179], v[140:143], 0
    s_branch LA2B_16
LA2A_15:
    s_waitcnt lgkmcnt(4)
    v_mfma_f32_16x16x32_bf16 v[0:3], v[160:163], v[128:131], v[0:3]
    ds_read_b128 v[144:147], v231 offset:0
    v_mfma_f32_16x16x32_bf16 v[4:7], v[160:163], v[132:135], v[4:7]
    s_add_u32 s84, s84, 16384
    v_mfma_f32_16x16x32_bf16 v[8:11], v[160:163], v[136:139], v[8:11]
    ds_read_b128 v[148:151], v231 offset:2048
    v_mfma_f32_16x16x32_bf16 v[12:15], v[160:163], v[140:143], v[12:15]
    s_and_b32 s84, s84, 0xffff
    s_waitcnt lgkmcnt(5)
    v_mfma_f32_16x16x32_bf16 v[16:19], v[164:167], v[128:131], v[16:19]
    ds_read_b128 v[152:155], v231 offset:4096
    v_mfma_f32_16x16x32_bf16 v[20:23], v[164:167], v[132:135], v[20:23]
    v_add_u32 v230, s84, v224
    v_mfma_f32_16x16x32_bf16 v[24:27], v[164:167], v[136:139], v[24:27]
    ds_read_b128 v[156:159], v231 offset:6144
    v_mfma_f32_16x16x32_bf16 v[28:31], v[164:167], v[140:143], v[28:31]
    s_add_u32 s85, s85, 20480
    s_waitcnt lgkmcnt(6)
    v_mfma_f32_16x16x32_bf16 v[32:35], v[168:171], v[128:131], v[32:35]
    ds_read_b128 v[192:195], v240 offset:10240
    v_mfma_f32_16x16x32_bf16 v[36:39], v[168:171], v[132:135], v[36:39]
    s_cmp_eq_u32 s85, 81920
    v_mfma_f32_16x16x32_bf16 v[40:43], v[168:171], v[136:139], v[40:43]
    ds_read_b128 v[196:199], v240 offset:11264
    v_mfma_f32_16x16x32_bf16 v[44:47], v[168:171], v[140:143], v[44:47]
    s_cselect_b32 s85, 0, s85
    s_waitcnt lgkmcnt(7)
    v_mfma_f32_16x16x32_bf16 v[48:51], v[172:175], v[128:131], v[48:51]
    ds_read_b128 v[200:203], v240 offset:12288
    v_mfma_f32_16x16x32_bf16 v[52:55], v[172:175], v[132:135], v[52:55]
    v_add_u32 v232, s85, v226
    v_mfma_f32_16x16x32_bf16 v[56:59], v[172:175], v[136:139], v[56:59]
    ds_read_b128 v[204:207], v240 offset:13312
    v_mfma_f32_16x16x32_bf16 v[60:63], v[172:175], v[140:143], v[60:63]
    s_waitcnt lgkmcnt(8)
    v_mfma_f32_16x16x32_bf16 v[64:67], v[176:179], v[128:131], v[64:67]
    ds_read_b128 v[208:211], v240 offset:14336
    v_mfma_f32_16x16x32_bf16 v[68:71], v[176:179], v[132:135], v[68:71]
    v_mfma_f32_16x16x32_bf16 v[72:75], v[176:179], v[136:139], v[72:75]
    v_mfma_f32_16x16x32_bf16 v[76:79], v[176:179], v[140:143], v[76:79]
LA2B_16:
    s_waitcnt lgkmcnt(4)
    v_mfma_f32_16x16x32_bf16 v[0:3], v[192:195], v[144:147], v[0:3]
    v_add_u32 v231, s84, v225
    v_mfma_f32_16x16x32_bf16 v[4:7], v[192:195], v[148:151], v[4:7]
    v_add_u32 v240, s85, v226
    v_mfma_f32_16x16x32_bf16 v[8:11], v[192:195], v[152:155], v[8:11]
    s_add_u32 s86, s86, 1
    v_mfma_f32_16x16x32_bf16 v[12:15], v[192:195], v[156:159], v[12:15]
    s_cmp_lt_u32 s86, s99
    s_waitcnt lgkmcnt(0)
    s_barrier
    v_mfma_f32_16x16x32_bf16 v[16:19], v[196:199], v[144:147], v[16:19]
    ds_read_b128 v[128:131], v230 offset:0
    v_mfma_f32_16x16x32_bf16 v[20:23], v[196:199], v[148:151], v[20:23]
    ds_read_b128 v[132:135], v230 offset:2048
    v_mfma_f32_16x16x32_bf16 v[24:27], v[196:199], v[152:155], v[24:27]
    v_mfma_f32_16x16x32_bf16 v[28:31], v[196:199], v[156:159], v[28:31]
    ds_read_b128 v[136:139], v230 offset:4096
    v_mfma_f32_16x16x32_bf16 v[32:35], v[200:203], v[144:147], v[32:35]
    v_mfma_f32_16x16x32_bf16 v[36:39], v[200:203], v[148:151], v[36:39]
    ds_read_b128 v[140:143], v230 offset:6144
    v_mfma_f32_16x16x32_bf16 v[40:43], v[200:203], v[152:155], v[40:43]
    ds_read_b128 v[160:163], v232 offset:0
    v_mfma_f32_16x16x32_bf16 v[44:47], v[200:203], v[156:159], v[44:47]
    v_mfma_f32_16x16x32_bf16 v[48:51], v[204:207], v[144:147], v[48:51]
    ds_read_b128 v[164:167], v232 offset:1024
    v_mfma_f32_16x16x32_bf16 v[52:55], v[204:207], v[148:151], v[52:55]
    v_mfma_f32_16x16x32_bf16 v[56:59], v[204:207], v[152:155], v[56:59]
    ds_read_b128 v[168:171], v232 offset:2048
    v_mfma_f32_16x16x32_bf16 v[60:63], v[204:207], v[156:159], v[60:63]
    ds_read_b128 v[172:175], v232 offset:3072
    v_mfma_f32_16x16x32_bf16 v[64:67], v[208:211], v[144:147], v[64:67]
    v_mfma_f32_16x16x32_bf16 v[68:71], v[208:211], v[148:151], v[68:71]
    ds_read_b128 v[176:179], v232 offset:4096
    v_mfma_f32_16x16x32_bf16 v[72:75], v[208:211], v[152:155], v[72:75]
    v_mfma_f32_16x16x32_bf16 v[76:79], v[208:211], v[156:159], v[76:79]
    s_cbranch_scc1 LA2A_15
    s_cmp_eq_u32 s99, 16
    s_cbranch_scc1 LA2X_17
    s_mov_b32 s99, 16
    s_waitcnt vmcnt(0)
    buffer_store_dword v253, v254, s[60:63], 0 offen offset:16 sc1
    s_branch LA2A_15
LA2X_17:
    s_waitcnt lgkmcnt(0)
    v_and_b32 v245, 15, v244
    v_lshrrev_b32 v246, 4, v244
    s_lshl_b32 s78, s87, 12
    v_lshlrev_b32 v247, 4, v244
    v_add_u32 v224, s78, v247
    v_add_u32 v225, 8192, v224
    v_bfe_u32 v247, v244, 2, 2
    v_and_b32 v248, 3, v244
    v_lshl_add_u32 v249, v246, 2, v247
    v_mul_u32_u24 v249, 320, v249
    v_lshl_add_u32 v249, v248, 3, v249
    v_and_b32 v248, 1, v246
    v_lshlrev_b32 v248, 5, v248
    s_mul_i32 s78, s88, 160
    s_add_u32 s78, s78, 65536
    v_add_u32 v249, s78, v249
    v_add_u32 v250, v249, v248
    v_sub_u32 v251, v249, v248
    s_cmp_eq_u32 s88, 0
    s_cselect_b64 vcc, -1, 0
    v_cndmask_b32 v226, v251, v250, vcc
    v_cndmask_b32 v227, v250, v251, vcc
    s_barrier
    v_add_u32 v230, s84, v224
    v_add_u32 v231, s84, v225
    v_add_u32 v232, s85, v226
    v_add_u32 v233, s85, v227
    ds_read_b128 v[128:131], v230 offset:0
    ds_read_b128 v[132:135], v230 offset:1024
    ds_read_b128 v[136:139], v230 offset:2048
    ds_read_b128 v[140:143], v230 offset:3072
    ds_read_b64_tr_b16 v[160:161], v232 offset:0
    ds_read_b64_tr_b16 v[162:163], v232 offset:5120
    ds_read_b64_tr_b16 v[164:165], v233 offset:32
    ds_read_b64_tr_b16 v[166:167], v233 offset:5152
    ds_read_b64_tr_b16 v[168:169], v232 offset:64
    ds_read_b64_tr_b16 v[170:171], v232 offset:5184
    ds_read_b64_tr_b16 v[172:173], v233 offset:96
    ds_read_b64_tr_b16 v[174:175], v233 offset:5216
    ds_read_b64_tr_b16 v[176:177], v232 offset:128
    ds_read_b64_tr_b16 v[178:179], v232 offset:5248
    v_add_u32 v240, s85, v226
    v_add_u32 v241, s85, v227
    s_nop 7
    v_mul_f32 v0, v236, v0
    v_mul_f32 v1, v236, v1
    v_mul_f32 v2, v236, v2
    v_mul_f32 v3, v236, v3
    v_mul_f32 v4, v237, v4
    v_mul_f32 v5, v237, v5
    v_mul_f32 v6, v237, v6
    v_mul_f32 v7, v237, v7
    v_mul_f32 v8, v238, v8
    v_mul_f32 v9, v238, v9
    v_mul_f32 v10, v238, v10
    v_mul_f32 v11, v238, v11
    v_mul_f32 v12, v239, v12
    v_mul_f32 v13, v239, v13
    v_mul_f32 v14, v239, v14
    v_mul_f32 v15, v239, v15
    v_mul_f32 v16, v236, v16
    v_mul_f32 v17, v236, v17
    v_mul_f32 v18, v236, v18
    v_mul_f32 v19, v236, v19
    v_mul_f32 v20, v237, v20
    v_mul_f32 v21, v237, v21
    v_mul_f32 v22, v237, v22
    v_mul_f32 v23, v237, v23
    v_mul_f32 v24, v238, v24
    v_mul_f32 v25, v238, v25
    v_mul_f32 v26, v238, v26
    v_mul_f32 v27, v238, v27
    v_mul_f32 v28, v239, v28
    v_mul_f32 v29, v239, v29
    v_mul_f32 v30, v239, v30
    v_mul_f32 v31, v239, v31
    v_mul_f32 v32, v236, v32
    v_mul_f32 v33, v236, v33
    v_mul_f32 v34, v236, v34
    v_mul_f32 v35, v236, v35
    v_mul_f32 v36, v237, v36
    v_mul_f32 v37, v237, v37
    v_mul_f32 v38, v237, v38
    v_mul_f32 v39, v237, v39
    v_mul_f32 v40, v238, v40
    v_mul_f32 v41, v238, v41
    v_mul_f32 v42, v238, v42
    v_mul_f32 v43, v238, v43
    v_mul_f32 v44, v239, v44
    v_mul_f32 v45, v239, v45
    v_mul_f32 v46, v239, v46
    v_mul_f32 v47, v239, v47
    v_mul_f32 v48, v236, v48
    v_mul_f32 v49, v236, v49
    v_mul_f32 v50, v236, v50
    v_mul_f32 v51, v236, v51
    v_mul_f32 v52, v237, v52
    v_mul_f32 v53, v237, v53
    v_mul_f32 v54, v237, v54
    v_mul_f32 v55, v237, v55
    v_mul_f32 v56, v238, v56
    v_mul_f32 v57, v238, v57
    v_mul_f32 v58, v238, v58
    v_mul_f32 v59, v238, v59
    v_mul_f32 v60, v239, v60
    v_mul_f32 v61, v239, v61
    v_mul_f32 v62, v239, v62
    v_mul_f32 v63, v239, v63
    v_mul_f32 v64, v236, v64
    v_mul_f32 v65, v236, v65
    v_mul_f32 v66, v236, v66
    v_mul_f32 v67, v236, v67
    v_mul_f32 v68, v237, v68
    v_mul_f32 v69, v237, v69
    v_mul_f32 v70, v237, v70
    v_mul_f32 v71, v237, v71
    v_mul_f32 v72, v238, v72
    v_mul_f32 v73, v238, v73
    v_mul_f32 v74, v238, v74
    v_mul_f32 v75, v238, v75
    v_mul_f32 v76, v239, v76
    v_mul_f32 v77, v239, v77
    v_mul_f32 v78, v239, v78
    v_mul_f32 v79, v239, v79
    s_nop 1
    s_mov_b32 s86, 0
    s_mov_b32 s99, 6
LB2A_18:
    s_waitcnt lgkmcnt(8)
    v_mfma_f32_16x16x32_bf16 v[0:3], v[160:163], v[128:131], v[0:3]
    ds_read_b128 v[144:147], v231 offset:0
    s_add_u32 s84, s84, 16384
    v_mfma_f32_16x16x32_bf16 v[4:7], v[160:163], v[132:135], v[4:7]
    ds_read_b128 v[148:151], v231 offset:1024
    s_and_b32 s84, s84, 0xffff
    v_mfma_f32_16x16x32_bf16 v[8:11], v[160:163], v[136:139], v[8:11]
    ds_read_b128 v[152:155], v231 offset:2048
    v_mfma_f32_16x16x32_bf16 v[12:15], v[160:163], v[140:143], v[12:15]
    v_add_u32 v230, s84, v224
    s_waitcnt lgkmcnt(9)
    v_mfma_f32_16x16x32_bf16 v[16:19], v[164:167], v[128:131], v[16:19]
    ds_read_b128 v[156:159], v231 offset:3072
    v_mfma_f32_16x16x32_bf16 v[20:23], v[164:167], v[132:135], v[20:23]
    ds_read_b64_tr_b16 v[192:193], v240 offset:10240
    v_mfma_f32_16x16x32_bf16 v[24:27], v[164:167], v[136:139], v[24:27]
    ds_read_b64_tr_b16 v[194:195], v240 offset:15360
    v_mfma_f32_16x16x32_bf16 v[28:31], v[164:167], v[140:143], v[28:31]
    s_add_u32 s85, s85, 20480
    s_waitcnt lgkmcnt(10)
    v_mfma_f32_16x16x32_bf16 v[32:35], v[168:171], v[128:131], v[32:35]
    ds_read_b64_tr_b16 v[196:197], v241 offset:10272
    v_mfma_f32_16x16x32_bf16 v[36:39], v[168:171], v[132:135], v[36:39]
    ds_read_b64_tr_b16 v[198:199], v241 offset:15392
    v_mfma_f32_16x16x32_bf16 v[40:43], v[168:171], v[136:139], v[40:43]
    ds_read_b64_tr_b16 v[200:201], v240 offset:10304
    v_mfma_f32_16x16x32_bf16 v[44:47], v[168:171], v[140:143], v[44:47]
    s_cmp_eq_u32 s85, 81920
    s_waitcnt lgkmcnt(11)
    v_mfma_f32_16x16x32_bf16 v[48:51], v[172:175], v[128:131], v[48:51]
    ds_read_b64_tr_b16 v[202:203], v240 offset:15424
    v_mfma_f32_16x16x32_bf16 v[52:55], v[172:175], v[132:135], v[52:55]
    ds_read_b64_tr_b16 v[204:205], v241 offset:10336
    v_mfma_f32_16x16x32_bf16 v[56:59], v[172:175], v[136:139], v[56:59]
    ds_read_b64_tr_b16 v[206:207], v241 offset:15456
    v_mfma_f32_16x16x32_bf16 v[60:63], v[172:175], v[140:143], v[60:63]
    s_cselect_b32 s85, 0, s85
    s_waitcnt lgkmcnt(12)
    v_mfma_f32_16x16x32_bf16 v[64:67], v[176:179], v[128:131], v[64:67]
    ds_read_b64_tr_b16 v[208:209], v240 offset:10368
    v_mfma_f32_16x16x32_bf16 v[68:71], v[176:179], v[132:135], v[68:71]
    ds_read_b64_tr_b16 v[210:211], v240 offset:15488
    v_mfma_f32_16x16x32_bf16 v[72:75], v[176:179], v[136:139], v[72:75]
    v_add_u32 v232, s85, v226
    v_mfma_f32_16x16x32_bf16 v[76:79], v[176:179], v[140:143], v[76:79]
    v_add_u32 v233, s85, v227
LB2B_19:
    s_waitcnt lgkmcnt(8)
    v_mfma_f32_16x16x32_bf16 v[0:3], v[192:195], v[144:147], v[0:3]
    v_add_u32 v231, s84, v225
    v_mfma_f32_16x16x32_bf16 v[4:7], v[192:195], v[148:151], v[4:7]
    v_add_u32 v240, s85, v226
    v_mfma_f32_16x16x32_bf16 v[8:11], v[192:195], v[152:155], v[8:11]
    v_add_u32 v241, s85, v227
    v_mfma_f32_16x16x32_bf16 v[12:15], v[192:195], v[156:159], v[12:15]
    s_add_u32 s86, s86, 1
    s_waitcnt lgkmcnt(0)
    s_barrier
    v_mfma_f32_16x16x32_bf16 v[16:19], v[196:199], v[144:147], v[16:19]
    ds_read_b128 v[128:131], v230 offset:0
    v_mfma_f32_16x16x32_bf16 v[20:23], v[196:199], v[148:151], v[20:23]
    ds_read_b128 v[132:135], v230 offset:1024
    v_mfma_f32_16x16x32_bf16 v[24:27], v[196:199], v[152:155], v[24:27]
    ds_read_b128 v[136:139], v230 offset:2048
    v_mfma_f32_16x16x32_bf16 v[28:31], v[196:199], v[156:159], v[28:31]
    ds_read_b128 v[140:143], v230 offset:3072
    v_mfma_f32_16x16x32_bf16 v[32:35], v[200:203], v[144:147], v[32:35]
    ds_read_b64_tr_b16 v[160:161], v232 offset:0
    v_mfma_f32_16x16x32_bf16 v[36:39], v[200:203], v[148:151], v[36:39]
    ds_read_b64_tr_b16 v[162:163], v232 offset:5120
    v_mfma_f32_16x16x32_bf16 v[40:43], v[200:203], v[152:155], v[40:43]
    ds_read_b64_tr_b16 v[164:165], v233 offset:32
    v_mfma_f32_16x16x32_bf16 v[44:47], v[200:203], v[156:159], v[44:47]
    ds_read_b64_tr_b16 v[166:167], v233 offset:5152
    v_mfma_f32_16x16x32_bf16 v[48:51], v[204:207], v[144:147], v[48:51]
    ds_read_b64_tr_b16 v[168:169], v232 offset:64
    v_mfma_f32_16x16x32_bf16 v[52:55], v[204:207], v[148:151], v[52:55]
    ds_read_b64_tr_b16 v[170:171], v232 offset:5184
    v_mfma_f32_16x16x32_bf16 v[56:59], v[204:207], v[152:155], v[56:59]
    ds_read_b64_tr_b16 v[172:173], v233 offset:96
    v_mfma_f32_16x16x32_bf16 v[60:63], v[204:207], v[156:159], v[60:63]
    ds_read_b64_tr_b16 v[174:175], v233 offset:5216
    v_mfma_f32_16x16x32_bf16 v[64:67], v[208:211], v[144:147], v[64:67]
    ds_read_b64_tr_b16 v[176:177], v232 offset:128
    v_mfma_f32_16x16x32_bf16 v[68:71], v[208:211], v[148:151], v[68:71]
    ds_read_b64_tr_b16 v[178:179], v232 offset:5248
    v_mfma_f32_16x16x32_bf16 v[72:75], v[208:211], v[152:155], v[72:75]
    s_cmp_lt_u32 s86, s99
    v_mfma_f32_16x16x32_bf16 v[76:79], v[208:211], v[156:159], v[76:79]
    s_cbranch_scc1 LB2A_18
    s_nop 7
    s_waitcnt lgkmcnt(0)
    v_lshlrev_b32 v252, 4, v244
    v_lshlrev_b32 v249, 3, v244
    s_mul_i32 s80, s75, 2560
    s_add_u32 s80, s80, 11534336
    s_nop 4
    s_xor_b32 s78, s2, 1
    s_lshl_b32 s78, s78, 2
    s_add_u32 s78, s78, 1
    s_mul_i32 s78, s78, 10240
    s_add_u32 s94, s78, s80
    v_cvt_pk_bf16_f32 v128, v4, v5
    v_cvt_pk_bf16_f32 v129, v6, v7
    v_cvt_pk_bf16_f32 v130, v20, v21
    v_cvt_pk_bf16_f32 v131, v22, v23
    buffer_store_dwordx4 v[128:131], v252, s[60:63], s94 offen sc1
    v_cvt_pk_bf16_f32 v132, v36, v37
    v_cvt_pk_bf16_f32 v133, v38, v39
    v_cvt_pk_bf16_f32 v134, v52, v53
    v_cvt_pk_bf16_f32 v135, v54, v55
    buffer_store_dwordx4 v[132:135], v252, s[60:63], s94 offen offset:1024 sc1
    v_cvt_pk_bf16_f32 v136, v68, v69
    v_cvt_pk_bf16_f32 v137, v70, v71
    buffer_store_dwordx2 v[136:137], v249, s[60:63], s94 offen offset:2048 sc1
    s_xor_b32 s78, s2, 2
    s_lshl_b32 s78, s78, 2
    s_add_u32 s78, s78, 2
    s_mul_i32 s78, s78, 10240
    s_add_u32 s94, s78, s80
    v_cvt_pk_bf16_f32 v140, v8, v9
    v_cvt_pk_bf16_f32 v141, v10, v11
    v_cvt_pk_bf16_f32 v142, v24, v25
    v_cvt_pk_bf16_f32 v143, v26, v27
    buffer_store_dwordx4 v[140:143], v252, s[60:63], s94 offen sc1
    v_cvt_pk_bf16_f32 v144, v40, v41
    v_cvt_pk_bf16_f32 v145, v42, v43
    v_cvt_pk_bf16_f32 v146, v56, v57
    v_cvt_pk_bf16_f32 v147, v58, v59
    buffer_store_dwordx4 v[144:147], v252, s[60:63], s94 offen offset:1024 sc1
    v_cvt_pk_bf16_f32 v148, v72, v73
    v_cvt_pk_bf16_f32 v149, v74, v75
    buffer_store_dwordx2 v[148:149], v249, s[60:63], s94 offen offset:2048 sc1
    s_xor_b32 s78, s2, 3
    s_lshl_b32 s78, s78, 2
    s_add_u32 s78, s78, 3
    s_mul_i32 s78, s78, 10240
    s_add_u32 s94, s78, s80
    v_cvt_pk_bf16_f32 v152, v12, v13
    v_cvt_pk_bf16_f32 v153, v14, v15
    v_cvt_pk_bf16_f32 v154, v28, v29
    v_cvt_pk_bf16_f32 v155, v30, v31
    buffer_store_dwordx4 v[152:155], v252, s[60:63], s94 offen sc1
    v_cvt_pk_bf16_f32 v156, v44, v45
    v_cvt_pk_bf16_f32 v157, v46, v47
    v_cvt_pk_bf16_f32 v158, v60, v61
    v_cvt_pk_bf16_f32 v159, v62, v63
    buffer_store_dwordx4 v[156:159], v252, s[60:63], s94 offen offset:1024 sc1
    v_cvt_pk_bf16_f32 v160, v76, v77
    v_cvt_pk_bf16_f32 v161, v78, v79
    buffer_store_dwordx2 v[160:161], v249, s[60:63], s94 offen offset:2048 sc1
    s_waitcnt vmcnt(0)
    s_lshl_b32 s78, s75, 2
    s_add_u32 s78, s78, 32
    s_mov_b64 exec, 1
    buffer_store_dword v253, v254, s[60:63], 0 offen offset:32 sc1
    s_mov_b64 exec, 7
    v_add_u32 v247, 1, v244
    v_xor_b32 v247, s2, v247
    v_lshlrev_b32 v247, 7, v247
    v_add_u32 v247, 32505856, v247
    s_mov_b32 s92, 0x20000
Lpoll_21:
    buffer_load_dword v248, v247, s[60:63], s78 offen sc1
    s_waitcnt vmcnt(0)
    v_cmp_ne_u32 vcc, 1, v248
    s_cbranch_vccz Lpd_22
    s_sleep 2
    s_sub_u32 s92, s92, 1
    s_cmp_lg_u32 s92, 0
    s_cbranch_scc1 Lpoll_21
Lpd_22:
    s_mov_b64 exec, -1
    s_lshl_b32 s78, s2, 2
    s_add_u32 s78, s78, 1
    s_mul_i32 s78, s78, 10240
    s_add_u32 s95, s78, s80
    s_lshl_b32 s78, s2, 2
    s_add_u32 s78, s78, 2
    s_mul_i32 s78, s78, 10240
    s_add_u32 s96, s78, s80
    s_lshl_b32 s78, s2, 2
    s_add_u32 s78, s78, 3
    s_mul_i32 s78, s78, 10240
    s_add_u32 s97, s78, s80
    buffer_load_dwordx4 v[128:131], v252, s[60:63], s95 offen sc1
    buffer_load_dwordx4 v[132:135], v252, s[60:63], s95 offen offset:1024 sc1
    buffer_load_dwordx2 v[136:137], v249, s[60:63], s95 offen offset:2048 sc1
    buffer_load_dwordx4 v[140:143], v252, s[60:63], s96 offen sc1
    buffer_load_dwordx4 v[144:147], v252, s[60:63], s96 offen offset:1024 sc1
    buffer_load_dwordx2 v[148:149], v249, s[60:63], s96 offen offset:2048 sc1
    buffer_load_dwordx4 v[152:155], v252, s[60:63], s97 offen sc1
    buffer_load_dwordx4 v[156:159], v252, s[60:63], s97 offen offset:1024 sc1
    buffer_load_dwordx2 v[160:161], v249, s[60:63], s97 offen offset:2048 sc1
    v_and_b32 v245, 15, v244
    s_lshl_b32 s78, s73, 7
    s_lshl_b32 s79, s87, 6
    s_add_u32 s78, s78, s79
    s_lshl_b32 s79, s72, 4
    s_add_u32 s78, s78, s79
    v_add_u32 v245, s78, v245
    v_mul_u32_u24 v245, 1280, v245
    v_lshrrev_b32 v246, 4, v244
    v_lshl_add_u32 v245, v246, 3, v245
    s_mul_i32 s78, s74, 320
    s_mul_i32 s79, s88, 160
    s_add_u32 s78, s78, s79
    v_add_u32 v245, s78, v245
    s_mov_b32 s79, 0xffff0000
    s_waitcnt vmcnt(0)
    v_lshlrev_b32 v168, 16, v128
    v_and_b32 v169, s79, v128
    v_lshlrev_b32 v170, 16, v129
    v_and_b32 v171, s79, v129
    v_lshlrev_b32 v172, 16, v140
    v_and_b32 v173, s79, v140
    v_lshlrev_b32 v174, 16, v141
    v_and_b32 v175, s79, v141
    v_lshlrev_b32 v176, 16, v152
    v_and_b32 v177, s79, v152
    v_lshlrev_b32 v178, 16, v153
    v_and_b32 v179, s79, v153
    v_add_f32 v0, v0, v168
    v_add_f32 v172, v172, v176
    v_add_f32 v1, v1, v169
    v_add_f32 v173, v173, v177
    v_add_f32 v2, v2, v170
    v_add_f32 v174, v174, v178
    v_add_f32 v3, v3, v171
    v_add_f32 v175, v175, v179
    v_add_f32 v0, v0, v172
    v_add_f32 v1, v1, v173
    v_add_f32 v2, v2, v174
    v_add_f32 v3, v3, v175
    v_cvt_pk_bf16_f32 v192, v0, v1
    v_cvt_pk_bf16_f32 v193, v2, v3
    buffer_store_dwordx2 v[192:193], v245, s[64:67], 0 offen offset:0
    v_lshlrev_b32 v168, 16, v130
    v_and_b32 v169, s79, v130
    v_lshlrev_b32 v170, 16, v131
    v_and_b32 v171, s79, v131
    v_lshlrev_b32 v172, 16, v142
    v_and_b32 v173, s79, v142
    v_lshlrev_b32 v174, 16, v143
    v_and_b32 v175, s79, v143
    v_lshlrev_b32 v176, 16, v154
    v_and_b32 v177, s79, v154
    v_lshlrev_b32 v178, 16, v155
    v_and_b32 v179, s79, v155
    v_add_f32 v16, v16, v168
    v_add_f32 v172, v172, v176
    v_add_f32 v17, v17, v169
    v_add_f32 v173, v173, v177
    v_add_f32 v18, v18, v170
    v_add_f32 v174, v174, v178
    v_add_f32 v19, v19, v171
    v_add_f32 v175, v175, v179
    v_add_f32 v16, v16, v172
    v_add_f32 v17, v17, v173
    v_add_f32 v18, v18, v174
    v_add_f32 v19, v19, v175
    v_cvt_pk_bf16_f32 v194, v16, v17
    v_cvt_pk_bf16_f32 v195, v18, v19
    buffer_store_dwordx2 v[194:195], v245, s[64:67], 0 offen offset:32
    v_lshlrev_b32 v168, 16, v132
    v_and_b32 v169, s79, v132
    v_lshlrev_b32 v170, 16, v133
    v_and_b32 v171, s79, v133
    v_lshlrev_b32 v172, 16, v144
    v_and_b32 v173, s79, v144
    v_lshlrev_b32 v174, 16, v145
    v_and_b32 v175, s79, v145
    v_lshlrev_b32 v176, 16, v156
    v_and_b32 v177, s79, v156
    v_lshlrev_b32 v178, 16, v157
    v_and_b32 v179, s79, v157
    v_add_f32 v32, v32, v168
    v_add_f32 v172, v172, v176
    v_add_f32 v33, v33, v169
    v_add_f32 v173, v173, v177
    v_add_f32 v34, v34, v170
    v_add_f32 v174, v174, v178
    v_add_f32 v35, v35, v171
    v_add_f32 v175, v175, v179
    v_add_f32 v32, v32, v172
    v_add_f32 v33, v33, v173
    v_add_f32 v34, v34, v174
    v_add_f32 v35, v35, v175
    v_cvt_pk_bf16_f32 v196, v32, v33
    v_cvt_pk_bf16_f32 v197, v34, v35
    buffer_store_dwordx2 v[196:197], v245, s[64:67], 0 offen offset:64
    v_lshlrev_b32 v168, 16, v134
    v_and_b32 v169, s79, v134
    v_lshlrev_b32 v170, 16, v135
    v_and_b32 v171, s79, v135
    v_lshlrev_b32 v172, 16, v146
    v_and_b32 v173, s79, v146
    v_lshlrev_b32 v174, 16, v147
    v_and_b32 v175, s79, v147
    v_lshlrev_b32 v176, 16, v158
    v_and_b32 v177, s79, v158
    v_lshlrev_b32 v178, 16, v159
    v_and_b32 v179, s79, v159
    v_add_f32 v48, v48, v168
    v_add_f32 v172, v172, v176
    v_add_f32 v49, v49, v169
    v_add_f32 v173, v173, v177
    v_add_f32 v50, v50, v170
    v_add_f32 v174, v174, v178
    v_add_f32 v51, v51, v171
    v_add_f32 v175, v175, v179
    v_add_f32 v48, v48, v172
    v_add_f32 v49, v49, v173
    v_add_f32 v50, v50, v174
    v_add_f32 v51, v51, v175
    v_cvt_pk_bf16_f32 v198, v48, v49
    v_cvt_pk_bf16_f32 v199, v50, v51
    buffer_store_dwordx2 v[198:199], v245, s[64:67], 0 offen offset:96
    v_lshlrev_b32 v168, 16, v136
    v_and_b32 v169, s79, v136
    v_lshlrev_b32 v170, 16, v137
    v_and_b32 v171, s79, v137
    v_lshlrev_b32 v172, 16, v148
    v_and_b32 v173, s79, v148
    v_lshlrev_b32 v174, 16, v149
    v_and_b32 v175, s79, v149
    v_lshlrev_b32 v176, 16, v160
    v_and_b32 v177, s79, v160
    v_lshlrev_b32 v178, 16, v161
    v_and_b32 v179, s79, v161
    v_add_f32 v64, v64, v168
    v_add_f32 v172, v172, v176
    v_add_f32 v65, v65, v169
    v_add_f32 v173, v173, v177
    v_add_f32 v66, v66, v170
    v_add_f32 v174, v174, v178
    v_add_f32 v67, v67, v171
    v_add_f32 v175, v175, v179
    v_add_f32 v64, v64, v172
    v_add_f32 v65, v65, v173
    v_add_f32 v66, v66, v174
    v_add_f32 v67, v67, v175
    v_cvt_pk_bf16_f32 v200, v64, v65
    v_cvt_pk_bf16_f32 v201, v66, v67
    buffer_store_dwordx2 v[200:201], v245, s[64:67], 0 offen offset:128
    s_endpgm
L_loader:
    s_sub_u32 s87, s75, 4
    v_lshrrev_b32 v1, 3, v0
    v_and_b32 v2, 7, v0
    s_lshl_b32 s88, s87, 12
    v_mov_b32 v66, 151040
    v_mov_b32 v64, 0
    ds_write_b32 v66, v64
    s_waitcnt lgkmcnt(0)
    s_cmp_lt_u32 s74, 2
    s_cbranch_scc0 L_loader_Y
    s_lshl_b32 s78, s73, 7
    s_lshl_b32 s79, s87, 5
    s_add_u32 s78, s78, s79
    v_add_u32 v16, s78, v1
    v_mul_u32_u24 v16, 1280, v16
    v_lshrrev_b32 v17, 1, v1
    v_or_b32 v18, 0, v17
    v_xor_b32 v18, v18, v2
    v_lshl_add_u32 v18, v18, 4, v16
    v_add_u32 v4, 0, v18
    v_or_b32 v18, 4, v17
    v_xor_b32 v18, v18, v2
    v_lshl_add_u32 v18, v18, 4, v16
    v_add_u32 v5, 9216, v18
    v_or_b32 v18, 0, v17
    v_xor_b32 v18, v18, v2
    v_lshl_add_u32 v18, v18, 4, v16
    v_add_u32 v6, 18432, v18
    v_or_b32 v18, 4, v17
    v_xor_b32 v18, v18, v2
    v_lshl_add_u32 v18, v18, 4, v16
    v_add_u32 v7, 27648, v18
    s_and_b32 s15, s73, 7
    s_mul_i32 s15, s15, 5
    s_lshr_b32 s15, s15, 2
    s_and_b32 s78, s74, 1
    s_mul_i32 s78, s78, 5
    s_add_u32 s15, s15, s78
    s_and_b32 s78, s74, 2
    s_add_u32 s15, s15, s78
    s_sub_u32 s78, s15, 10
    s_cmp_ge_u32 s15, 10
    s_cselect_b32 s15, s78, s15
    s_mul_i32 s90, s15, 128
    s_add_u32 m0, s88, 0
    s_nop 0
    buffer_load_dwordx4 v4, s[32:35], s90 offen lds
    buffer_load_dwordx4 v5, s[32:35], s90 offen offset:1024 lds
    buffer_load_dwordx4 v6, s[32:35], s90 offen offset:2048 lds
    buffer_load_dwordx4 v7, s[32:35], s90 offen offset:3072 lds
    s_add_u32 s90, s90, 128
    s_cmp_eq_u32 s90, 1280
    s_cselect_b32 s90, 0, s90
    s_mul_i32 s78, s72, 6
    s_lshr_b32 s80, s87, 1
    s_lshl_b32 s79, s74, 1
    s_add_u32 s78, s78, s79
    s_add_u32 s78, s78, s80
    s_lshl_b32 s78, s78, 7
    v_mul_u32_u24 v16, 3072, v1
    v_add_u32 v16, s78, v16
    v_and_b32 v17, 2, v1
    v_or_b32 v18, 0, v17
    v_xor_b32 v18, v18, v2
    v_lshl_add_u32 v18, v18, 4, v16
    v_add_u32 v8, 0, v18
    v_or_b32 v18, 4, v17
    v_xor_b32 v18, v18, v2
    v_lshl_add_u32 v18, v18, 4, v16
    v_add_u32 v9, 23552, v18
    v_or_b32 v18, 0, v17
    v_xor_b32 v18, v18, v2
    v_lshl_add_u32 v18, v18, 4, v16
    v_add_u32 v10, 47104, v18
    v_or_b32 v18, 4, v17
    v_xor_b32 v18, v18, v2
    v_lshl_add_u32 v18, v18, 4, v16
    v_add_u32 v11, 70656, v18
    s_lshl_b32 s89, s87, 12
    s_and_b32 s15, s73, 7
    s_mul_i32 s15, s15, 5
    s_lshr_b32 s15, s15, 2
    s_and_b32 s78, s74, 1
    s_mul_i32 s78, s78, 5
    s_add_u32 s15, s15, s78
    s_and_b32 s78, s74, 2
    s_add_u32 s15, s15, s78
    s_sub_u32 s78, s15, 10
    s_cmp_ge_u32 s15, 10
    s_cselect_b32 s15, s78, s15
    s_mul_i32 s91, s15, 196608
    s_add_u32 m0, s89, 65536
    s_nop 0
    buffer_load_dwordx4 v8, s[48:51], s91 offen lds
    buffer_load_dwordx4 v9, s[48:51], s91 offen offset:1024 lds
    buffer_load_dwordx4 v10, s[48:51], s91 offen offset:2048 lds
    buffer_load_dwordx4 v11, s[48:51], s91 offen offset:3072 lds
    s_add_u32 s91, s91, 98304
    s_cmp_eq_u32 s91, 1966080
    s_cselect_b32 s91, 0, s91
    s_add_u32 m0, s89, 86016
    s_nop 0
    buffer_load_dwordx4 v8, s[48:51], s91 offen lds
    buffer_load_dwordx4 v9, s[48:51], s91 offen offset:1024 lds
    buffer_load_dwordx4 v10, s[48:51], s91 offen offset:2048 lds
    buffer_load_dwordx4 v11, s[48:51], s91 offen offset:3072 lds
    s_add_u32 s91, s91, 98304
    s_cmp_eq_u32 s91, 1966080
    s_cselect_b32 s91, 0, s91
    s_add_u32 m0, s89, 106496
    s_nop 0
    buffer_load_dwordx4 v8, s[48:51], s91 offen lds
    buffer_load_dwordx4 v9, s[48:51], s91 offen offset:1024 lds
    buffer_load_dwordx4 v10, s[48:51], s91 offen offset:2048 lds
    buffer_load_dwordx4 v11, s[48:51], s91 offen offset:3072 lds
    s_add_u32 s91, s91, 98304
    s_cmp_eq_u32 s91, 1966080
    s_cselect_b32 s91, 0, s91
    s_waitcnt vmcnt(8)
    s_barrier
    s_add_u32 m0, s88, 16384
    s_nop 0
    buffer_load_dwordx4 v4, s[32:35], s90 offen lds
    buffer_load_dwordx4 v5, s[32:35], s90 offen offset:1024 lds
    buffer_load_dwordx4 v6, s[32:35], s90 offen offset:2048 lds
    buffer_load_dwordx4 v7, s[32:35], s90 offen offset:3072 lds
    s_add_u32 s90, s90, 128
    s_cmp_eq_u32 s90, 1280
    s_cselect_b32 s90, 0, s90
    s_add_u32 m0, s89, 126976
    s_nop 0
    buffer_load_dwordx4 v8, s[48:51], s91 offen lds
    buffer_load_dwordx4 v9, s[48:51], s91 offen offset:1024 lds
    buffer_load_dwordx4 v10, s[48:51], s91 offen offset:2048 lds
    buffer_load_dwordx4 v11, s[48:51], s91 offen offset:3072 lds
    s_add_u32 s91, s91, 98304
    s_cmp_eq_u32 s91, 1966080
    s_cselect_b32 s91, 0, s91
    s_add_u32 m0, s88, 32768
    s_nop 0
    buffer_load_dwordx4 v4, s[32:35], s90 offen lds
    buffer_load_dwordx4 v5, s[32:35], s90 offen offset:1024 lds
    buffer_load_dwordx4 v6, s[32:35], s90 offen offset:2048 lds
    buffer_load_dwordx4 v7, s[32:35], s90 offen offset:3072 lds
    s_add_u32 s90, s90, 128
    s_cmp_eq_u32 s90, 1280
    s_cselect_b32 s90, 0, s90
    s_waitcnt vmcnt(16)
    s_barrier
    s_add_u32 m0, s89, 65536
    s_nop 0
    buffer_load_dwordx4 v8, s[48:51], s91 offen lds
    buffer_load_dwordx4 v9, s[48:51], s91 offen offset:1024 lds
    buffer_load_dwordx4 v10, s[48:51], s91 offen offset:2048 lds
    buffer_load_dwordx4 v11, s[48:51], s91 offen offset:3072 lds
    s_add_u32 s91, s91, 98304
    s_cmp_eq_u32 s91, 1966080
    s_cselect_b32 s91, 0, s91
    s_add_u32 m0, s88, 49152
    s_nop 0
    buffer_load_dwordx4 v4, s[32:35], s90 offen lds
    buffer_load_dwordx4 v5, s[32:35], s90 offen offset:1024 lds
    buffer_load_dwordx4 v6, s[32:35], s90 offen offset:2048 lds
    buffer_load_dwordx4 v7, s[32:35], s90 offen offset:3072 lds
    s_add_u32 s90, s90, 128
    s_cmp_eq_u32 s90, 1280
    s_cselect_b32 s90, 0, s90
    s_waitcnt vmcnt(16)
    s_barrier
    s_add_u32 m0, s89, 86016
    s_nop 0
    buffer_load_dwordx4 v8, s[48:51], s91 offen lds
    buffer_load_dwordx4 v9, s[48:51], s91 offen offset:1024 lds
    buffer_load_dwordx4 v10, s[48:51], s91 offen offset:2048 lds
    buffer_load_dwordx4 v11, s[48:51], s91 offen offset:3072 lds
    s_add_u32 s91, s91, 98304
    s_cmp_eq_u32 s91, 1966080
    s_cselect_b32 s91, 0, s91
    s_add_u32 m0, s88, 0
    s_nop 0
    buffer_load_dwordx4 v4, s[32:35], s90 offen lds
    buffer_load_dwordx4 v5, s[32:35], s90 offen offset:1024 lds
    buffer_load_dwordx4 v6, s[32:35], s90 offen offset:2048 lds
    buffer_load_dwordx4 v7, s[32:35], s90 offen offset:3072 lds
    s_add_u32 s90, s90, 128
    s_cmp_eq_u32 s90, 1280
    s_cselect_b32 s90, 0, s90
    s_waitcnt vmcnt(20)
    s_barrier
    s_add_u32 m0, s89, 106496
    s_nop 0
    buffer_load_dwordx4 v8, s[48:51], s91 offen lds
    buffer_load_dwordx4 v9, s[48:51], s91 offen offset:1024 lds
    buffer_load_dwordx4 v10, s[48:51], s91 offen offset:2048 lds
    buffer_load_dwordx4 v11, s[48:51], s91 offen offset:3072 lds
    s_add_u32 s91, s91, 98304
    s_cmp_eq_u32 s91, 1966080
    s_cselect_b32 s91, 0, s91
    v_lshlrev_b32 v64, 2, v2
    buffer_load_dword v72, v64, s[68:71], 0 offen
    s_waitcnt vmcnt(17)
    s_barrier
    s_add_u32 m0, s89, 126976
    s_nop 0
    buffer_load_dwordx4 v8, s[48:51], s91 offen lds
    buffer_load_dwordx4 v9, s[48:51], s91 offen offset:1024 lds
    buffer_load_dwordx4 v10, s[48:51], s91 offen offset:2048 lds
    buffer_load_dwordx4 v11, s[48:51], s91 offen offset:3072 lds
    s_add_u32 s91, s91, 98304
    s_cmp_eq_u32 s91, 1966080
    s_cselect_b32 s91, 0, s91
    s_add_u32 m0, s88, 16384
    s_nop 0
    buffer_load_dwordx4 v4, s[32:35], s90 offen lds
    buffer_load_dwordx4 v5, s[32:35], s90 offen offset:1024 lds
    buffer_load_dwordx4 v6, s[32:35], s90 offen offset:2048 lds
    buffer_load_dwordx4 v7, s[32:35], s90 offen offset:3072 lds
    s_add_u32 s90, s90, 128
    s_cmp_eq_u32 s90, 1280
    s_cselect_b32 s90, 0, s90
    s_waitcnt vmcnt(17)
    s_barrier
    s_add_u32 m0, s89, 65536
    s_nop 0
    buffer_load_dwordx4 v8, s[48:51], s91 offen lds
    buffer_load_dwordx4 v9, s[48:51], s91 offen offset:1024 lds
    buffer_load_dwordx4 v10, s[48:51], s91 offen offset:2048 lds
    buffer_load_dwordx4 v11, s[48:51], s91 offen offset:3072 lds
    s_add_u32 s91, s91, 98304
    s_cmp_eq_u32 s91, 1966080
    s_cselect_b32 s91, 0, s91
    s_waitcnt vmcnt(13)
    s_barrier
    s_add_u32 m0, s89, 86016
    s_nop 0
    buffer_load_dwordx4 v8, s[48:51], s91 offen lds
    buffer_load_dwordx4 v9, s[48:51], s91 offen offset:1024 lds
    buffer_load_dwordx4 v10, s[48:51], s91 offen offset:2048 lds
    buffer_load_dwordx4 v11, s[48:51], s91 offen offset:3072 lds
    s_add_u32 s91, s91, 98304
    s_cmp_eq_u32 s91, 1966080
    s_cselect_b32 s91, 0, s91
    s_add_u32 m0, s88, 32768
    s_nop 0
    buffer_load_dwordx4 v4, s[32:35], s90 offen lds
    buffer_load_dwordx4 v5, s[32:35], s90 offen offset:1024 lds
    buffer_load_dwordx4 v6, s[32:35], s90 offen offset:2048 lds
    buffer_load_dwordx4 v7, s[32:35], s90 offen offset:3072 lds
    s_add_u32 s90, s90, 128
    s_cmp_eq_u32 s90, 1280
    s_cselect_b32 s90, 0, s90
    s_waitcnt vmcnt(16)
    v_cmp_ne_u32 vcc, 1, v72
    s_cbranch_vccz Lok_23
    s_mov_b32 s92, 0x20000
Lpoll_24:
    buffer_load_dword v72, v64, s[68:71], 0 offen sc1
    s_waitcnt vmcnt(0)
    v_cmp_ne_u32 vcc, 1, v72
    s_cbranch_vccz Lpd_25
    s_sleep 16
    s_sub_u32 s92, s92, 1
    s_cmp_lg_u32 s92, 0
    s_cbranch_scc1 Lpoll_24
Lpd_25:
Lok_23:
    s_barrier
    s_add_u32 m0, s89, 106496
    s_nop 0
    buffer_load_dwordx4 v8, s[48:51], s91 offen lds
    buffer_load_dwordx4 v9, s[48:51], s91 offen offset:1024 lds
    buffer_load_dwordx4 v10, s[48:51], s91 offen offset:2048 lds
    buffer_load_dwordx4 v11, s[48:51], s91 offen offset:3072 lds
    s_add_u32 s91, s91, 98304
    s_cmp_eq_u32 s91, 1966080
    s_cselect_b32 s91, 0, s91
    s_waitcnt vmcnt(12)
    s_barrier
    s_add_u32 m0, s89, 126976
    s_nop 0
    buffer_load_dwordx4 v8, s[48:51], s91 offen lds
    buffer_load_dwordx4 v9, s[48:51], s91 offen offset:1024 lds
    buffer_load_dwordx4 v10, s[48:51], s91 offen offset:2048 lds
    buffer_load_dwordx4 v11, s[48:51], s91 offen offset:3072 lds
    s_add_u32 s91, s91, 98304
    s_cmp_eq_u32 s91, 1966080
    s_cselect_b32 s91, 0, s91
    s_add_u32 m0, s88, 49152
    s_nop 0
    buffer_load_dwordx4 v4, s[32:35], s90 offen lds
    buffer_load_dwordx4 v5, s[32:35], s90 offen offset:1024 lds
    buffer_load_dwordx4 v6, s[32:35], s90 offen offset:2048 lds
    buffer_load_dwordx4 v7, s[32:35], s90 offen offset:3072 lds
    s_add_u32 s90, s90, 128
    s_cmp_eq_u32 s90, 1280
    s_cselect_b32 s90, 0, s90
    s_waitcnt vmcnt(16)
    s_barrier
    s_add_u32 m0, s89, 65536
    s_nop 0
    buffer_load_dwordx4 v8, s[48:51], s91 offen lds
    buffer_load_dwordx4 v9, s[48:51], s91 offen offset:1024 lds
    buffer_load_dwordx4 v10, s[48:51], s91 offen offset:2048 lds
    buffer_load_dwordx4 v11, s[48:51], s91 offen offset:3072 lds
    s_add_u32 s91, s91, 98304
    s_cmp_eq_u32 s91, 1966080
    s_cselect_b32 s91, 0, s91
    s_waitcnt vmcnt(12)
    s_barrier
    s_add_u32 m0, s89, 86016
    s_nop 0
    buffer_load_dwordx4 v8, s[48:51], s91 offen lds
    buffer_load_dwordx4 v9, s[48:51], s91 offen offset:1024 lds
    buffer_load_dwordx4 v10, s[48:51], s91 offen offset:2048 lds
    buffer_load_dwordx4 v11, s[48:51], s91 offen offset:3072 lds
    s_add_u32 s91, s91, 98304
    s_cmp_eq_u32 s91, 1966080
    s_cselect_b32 s91, 0, s91
    s_add_u32 m0, s88, 0
    s_nop 0
    buffer_load_dwordx4 v4, s[32:35], s90 offen lds
    buffer_load_dwordx4 v5, s[32:35], s90 offen offset:1024 lds
    buffer_load_dwordx4 v6, s[32:35], s90 offen offset:2048 lds
    buffer_load_dwordx4 v7, s[32:35], s90 offen offset:3072 lds
    s_add_u32 s90, s90, 128
    s_cmp_eq_u32 s90, 1280
    s_cselect_b32 s90, 0, s90
    s_waitcnt vmcnt(16)
    s_barrier
    s_add_u32 m0, s89, 106496
    s_nop 0
    buffer_load_dwordx4 v8, s[48:51], s91 offen lds
    buffer_load_dwordx4 v9, s[48:51], s91 offen offset:1024 lds
    buffer_load_dwordx4 v10, s[48:51], s91 offen offset:2048 lds
    buffer_load_dwordx4 v11, s[48:51], s91 offen offset:3072 lds
    s_add_u32 s91, s91, 98304
    s_cmp_eq_u32 s91, 1966080
    s_cselect_b32 s91, 0, s91
    s_waitcnt vmcnt(12)
    s_barrier
    s_add_u32 m0, s89, 126976
    s_nop 0
    buffer_load_dwordx4 v8, s[48:51], s91 offen lds
    buffer_load_dwordx4 v9, s[48:51], s91 offen offset:1024 lds
    buffer_load_dwordx4 v10, s[48:51], s91 offen offset:2048 lds
    buffer_load_dwordx4 v11, s[48:51], s91 offen offset:3072 lds
    s_add_u32 s91, s91, 98304
    s_cmp_eq_u32 s91, 1966080
    s_cselect_b32 s91, 0, s91
    s_add_u32 m0, s88, 16384
    s_nop 0
    buffer_load_dwordx4 v4, s[32:35], s90 offen lds
    buffer_load_dwordx4 v5, s[32:35], s90 offen offset:1024 lds
    buffer_load_dwordx4 v6, s[32:35], s90 offen offset:2048 lds
    buffer_load_dwordx4 v7, s[32:35], s90 offen offset:3072 lds
    s_add_u32 s90, s90, 128
    s_cmp_eq_u32 s90, 1280
    s_cselect_b32 s90, 0, s90
    s_waitcnt vmcnt(16)
    s_barrier
    s_add_u32 m0, s89, 65536
    s_nop 0
    buffer_load_dwordx4 v8, s[48:51], s91 offen lds
    buffer_load_dwordx4 v9, s[48:51], s91 offen offset:1024 lds
    buffer_load_dwordx4 v10, s[48:51], s91 offen offset:2048 lds
    buffer_load_dwordx4 v11, s[48:51], s91 offen offset:3072 lds
    s_add_u32 s91, s91, 98304
    s_cmp_eq_u32 s91, 1966080
    s_cselect_b32 s91, 0, s91
    s_waitcnt vmcnt(12)
    s_barrier
    s_add_u32 m0, s89, 86016
    s_nop 0
    buffer_load_dwordx4 v8, s[48:51], s91 offen lds
    buffer_load_dwordx4 v9, s[48:51], s91 offen offset:1024 lds
    buffer_load_dwordx4 v10, s[48:51], s91 offen offset:2048 lds
    buffer_load_dwordx4 v11, s[48:51], s91 offen offset:3072 lds
    s_add_u32 s91, s91, 98304
    s_cmp_eq_u32 s91, 1966080
    s_cselect_b32 s91, 0, s91
    v_lshrrev_b32 v17, 1, v1
    s_lshl_b32 s78, s87, 5
    s_lshl_b32 s79, s72, 4
    s_lshl_b32 s80, s73, 7
    s_lshl_b32 s81, s72, 10
    s_add_u32 s81, s81, 4096
    s_add_u32 s82, s78, 0
    s_xor_b32 s82, s82, s79
    s_add_u32 s82, s82, s80
    v_add_u32 v16, s82, v1
    v_lshlrev_b32 v16, 12, v16
    v_or_b32 v18, 0, v17
    v_xor_b32 v18, v18, v2
    v_lshl_add_u32 v18, v18, 4, v16
    s_sub_u32 s82, s81, 0
    v_add_u32 v4, s82, v18
    s_add_u32 s82, s78, 8
    s_xor_b32 s82, s82, s79
    s_add_u32 s82, s82, s80
    v_add_u32 v16, s82, v1
    v_lshlrev_b32 v16, 12, v16
    v_or_b32 v18, 4, v17
    v_xor_b32 v18, v18, v2
    v_lshl_add_u32 v18, v18, 4, v16
    s_sub_u32 s82, s81, 1024
    v_add_u32 v5, s82, v18
    s_add_u32 s82, s78, 16
    s_xor_b32 s82, s82, s79
    s_add_u32 s82, s82, s80
    v_add_u32 v16, s82, v1
    v_lshlrev_b32 v16, 12, v16
    v_or_b32 v18, 0, v17
    v_xor_b32 v18, v18, v2
    v_lshl_add_u32 v18, v18, 4, v16
    s_sub_u32 s82, s81, 2048
    v_add_u32 v6, s82, v18
    s_add_u32 s82, s78, 24
    s_xor_b32 s82, s82, s79
    s_add_u32 s82, s82, s80
    v_add_u32 v16, s82, v1
    v_lshlrev_b32 v16, 12, v16
    v_or_b32 v18, 4, v17
    v_xor_b32 v18, v18, v2
    v_lshl_add_u32 v18, v18, 4, v16
    s_sub_u32 s82, s81, 3072
    v_add_u32 v7, s82, v18
    s_lshl_b32 s15, s74, 1
    s_add_u32 s15, s15, s73
    s_lshl_b32 s15, s15, 1
    s_and_b32 s15, s15, 15
    s_mov_b32 s12, s15
    s_mov_b32 s10, 8392704
    s_mov_b32 s11, 0x20000
    s_cmp_lt_u32 s12, 8
    s_cselect_b32 s8, s36, s40
    s_cselect_b32 s9, s37, s41
    s_and_b32 s90, s12, 7
    s_lshl_b32 s90, s90, 7
    s_add_u32 m0, s88, 32768
    s_nop 0
    buffer_load_dwordx4 v4, s[8:11], s90 offen lds
    buffer_load_dwordx4 v5, s[8:11], s90 offen offset:1024 lds
    buffer_load_dwordx4 v6, s[8:11], s90 offen offset:2048 lds
    buffer_load_dwordx4 v7, s[8:11], s90 offen offset:3072 lds
    s_add_u32 s12, s12, 1
    s_and_b32 s12, s12, 15
    s_andn2_b32 s78, s2, 0x1b
    v_and_b32 v16, 3, v0
    v_lshlrev_b32 v16, 3, v16
    v_bfe_u32 v17, v0, 2, 2
    v_add3_u32 v64, v16, v17, s78
    v_lshlrev_b32 v64, 7, v64
    v_add_u32 v64, 32505916, v64
    buffer_load_dword v72, v64, s[60:63], 0 offen sc1
    s_waitcnt vmcnt(17)
    s_barrier
    s_add_u32 m0, s89, 106496
    s_nop 0
    buffer_load_dwordx4 v8, s[48:51], s91 offen lds
    buffer_load_dwordx4 v9, s[48:51], s91 offen offset:1024 lds
    buffer_load_dwordx4 v10, s[48:51], s91 offen offset:2048 lds
    buffer_load_dwordx4 v11, s[48:51], s91 offen offset:3072 lds
    s_add_u32 s91, s91, 98304
    s_cmp_eq_u32 s91, 1966080
    s_cselect_b32 s91, 0, s91
    s_waitcnt vmcnt(13)
    s_barrier
    s_waitcnt vmcnt(4)
    v_cmp_ne_u32 vcc, 1, v72
    s_cbranch_vccz Lok_26
    s_mov_b32 s92, 0x20000
Lpoll_27:
    buffer_load_dword v72, v64, s[60:63], 0 offen sc1
    s_waitcnt vmcnt(0)
    v_cmp_ne_u32 vcc, 1, v72
    s_cbranch_vccz Lpd_28
    s_sleep 8
    s_sub_u32 s92, s92, 1
    s_cmp_lg_u32 s92, 0
    s_cbranch_scc1 Lpoll_27
Lpd_28:
Lok_26:
    v_and_b32 v16, 31, v0
    v_lshlrev_b32 v60, 2, v16
    s_lshl_b32 s78, s73, 9
    s_lshl_b32 s79, s87, 7
    s_add_u32 s78, s78, s79
    s_add_u32 s78, s78, 32538624
    buffer_load_dword v32, v60, s[60:63], s78 offen sc1
    s_add_u32 m0, s89, 126976
    s_nop 0
    buffer_load_dwordx4 v8, s[48:51], s91 offen lds
    buffer_load_dwordx4 v9, s[48:51], s91 offen offset:1024 lds
    buffer_load_dwordx4 v10, s[48:51], s91 offen offset:2048 lds
    buffer_load_dwordx4 v11, s[48:51], s91 offen offset:3072 lds
    s_add_u32 s91, s91, 98304
    s_cmp_eq_u32 s91, 1966080
    s_cselect_b32 s91, 0, s91
    s_cmp_lt_u32 s12, 8
    s_cselect_b32 s8, s36, s40
    s_cselect_b32 s9, s37, s41
    s_and_b32 s90, s12, 7
    s_lshl_b32 s90, s90, 7
    s_add_u32 m0, s88, 49152
    s_nop 0
    buffer_load_dwordx4 v4, s[8:11], s90 offen lds
    buffer_load_dwordx4 v5, s[8:11], s90 offen offset:1024 lds
    buffer_load_dwordx4 v6, s[8:11], s90 offen offset:2048 lds
    buffer_load_dwordx4 v7, s[8:11], s90 offen offset:3072 lds
    s_add_u32 s12, s12, 1
    s_and_b32 s12, s12, 15
    s_barrier
    s_waitcnt vmcnt(9)
    s_barrier
    s_cmp_lt_u32 s12, 8
    s_cselect_b32 s8, s36, s40
    s_cselect_b32 s9, s37, s41
    s_and_b32 s90, s12, 7
    s_lshl_b32 s90, s90, 7
    s_add_u32 m0, s88, 0
    s_nop 0
    buffer_load_dwordx4 v4, s[8:11], s90 offen lds
    buffer_load_dwordx4 v5, s[8:11], s90 offen offset:1024 lds
    buffer_load_dwordx4 v6, s[8:11], s90 offen offset:2048 lds
    buffer_load_dwordx4 v7, s[8:11], s90 offen offset:3072 lds
    s_add_u32 s12, s12, 1
    s_and_b32 s12, s12, 15
    v_and_b32 v16, 3, v0
    s_lshl_b32 s78, s72, 2
    v_add_u32 v16, s78, v16
    v_and_b32 v17, 4, v0
    v_add_u32 v17, s74, v17
    v_and_b32 v18, 7, v16
    v_lshlrev_b32 v18, 5, v18
    v_and_b32 v19, 1, v17
    v_add_u32 v19, 2, v19
    v_lshl_add_u32 v18, v19, 3, v18
    v_lshrrev_b32 v19, 3, v16
    v_lshl_add_u32 v18, v19, 2, v18
    v_lshrrev_b32 v19, 1, v17
    v_add_u32 v65, v18, v19
    v_lshlrev_b32 v65, 7, v65
    v_add_u32 v65, 32505856, v65
    buffer_load_dwordx4 v[76:79], v65, s[60:63], 0 offen sc1
    s_waitcnt vmcnt(9)
    s_barrier
    s_mov_b32 s78, 0x3fb8aa3b
    s_mov_b32 s79, 0x42ad1f97
    s_lshl_b32 s80, s87, 7
    s_add_u32 s80, s80, 147456
    v_add_u32 v24, s80, v60
    v_mul_f32 v32, s78, v32
    v_min_f32 v16, s79, v32
    v_exp_f32 v16, v16
    v_exp_f32 v17, -v32
    s_nop 0
    v_add_f32 v16, 1.0, v16
    v_add_f32 v17, 1.0, v17
    v_rcp_f32 v17, v17
    s_nop 0
    ds_write_b32 v24, v16 offset:2048
    ds_write_b32 v24, v17 offset:2560
    s_waitcnt lgkmcnt(0)
    s_barrier
    s_lshl_b32 s78, s74, 6
    s_lshl_b32 s79, s72, 4
    s_add_u32 s78, s78, s79
    s_mul_i32 s78, s78, 10240
    s_mul_i32 s79, s87, 5120
    s_add_u32 s78, s78, s79
    s_add_u32 s78, s78, 0
    v_lshlrev_b32 v16, 4, v0
    v_add_u32 v8, s78, v16
    v_add_u32 v9, s78, v16
    v_add_u32 v10, s78, v16
    v_add_u32 v11, s78, v16
    v_add_u32 v12, 4096, v8
    s_mul_i32 s89, s87, 5120
    s_lshl_b32 s15, s74, 1
    s_add_u32 s15, s15, s73
    s_lshl_b32 s15, s15, 1
    s_and_b32 s15, s15, 15
    s_mov_b32 s13, s15
    s_waitcnt vmcnt(0)
    v_and_b32 v76, v76, v77
    v_and_b32 v78, v78, v79
    v_and_b32 v76, v76, v78
    v_cmp_ne_u32 vcc, 1, v76
    s_cbranch_vccz Lok_29
    s_mov_b32 s92, 0x20000
Lpoll_30:
    buffer_load_dwordx4 v[76:79], v65, s[60:63], 0 offen sc1
    s_waitcnt vmcnt(0)
    v_and_b32 v76, v76, v77
    v_and_b32 v78, v78, v79
    v_and_b32 v76, v76, v78
    v_cmp_ne_u32 vcc, 1, v76
    s_cbranch_vccz Lpd_31
    s_sleep 2
    s_sub_u32 s92, s92, 1
    s_cmp_lg_u32 s92, 0
    s_cbranch_scc1 Lpoll_30
Lpd_31:
Lok_29:
    s_lshr_b32 s78, s13, 3
    s_mul_i32 s78, s78, 2621440
    s_and_b32 s91, s13, 7
    s_mul_i32 s91, s91, 20480
    s_add_u32 s91, s91, s78
    s_add_u32 m0, s89, 65536
    s_nop 0
    buffer_load_dwordx4 v8, s[60:63], s91 offen sc1 lds
    buffer_load_dwordx4 v9, s[60:63], s91 offen offset:1024 sc1 lds
    buffer_load_dwordx4 v10, s[60:63], s91 offen offset:2048 sc1 lds
    buffer_load_dwordx4 v11, s[60:63], s91 offen offset:3072 sc1 lds
    s_add_u32 m0, s89, 69632
    s_nop 0
    buffer_load_dwordx4 v12, s[60:63], s91 offen sc1 lds
    s_add_u32 s13, s13, 1
    s_and_b32 s13, s13, 15
    s_cmp_lt_u32 s12, 8
    s_cselect_b32 s8, s36, s40
    s_cselect_b32 s9, s37, s41
    s_and_b32 s90, s12, 7
    s_lshl_b32 s90, s90, 7
    s_add_u32 m0, s88, 16384
    s_nop 0
    buffer_load_dwordx4 v4, s[8:11], s90 offen lds
    buffer_load_dwordx4 v5, s[8:11], s90 offen offset:1024 lds
    buffer_load_dwordx4 v6, s[8:11], s90 offen offset:2048 lds
    buffer_load_dwordx4 v7, s[8:11], s90 offen offset:3072 lds
    s_add_u32 s12, s12, 1
    s_and_b32 s12, s12, 15
    s_waitcnt vmcnt(4)
    s_barrier
    s_lshr_b32 s78, s13, 3
    s_mul_i32 s78, s78, 2621440
    s_and_b32 s91, s13, 7
    s_mul_i32 s91, s91, 20480
    s_add_u32 s91, s91, s78
    s_add_u32 m0, s89, 86016
    s_nop 0
    buffer_load_dwordx4 v8, s[60:63], s91 offen sc1 lds
    buffer_load_dwordx4 v9, s[60:63], s91 offen offset:1024 sc1 lds
    buffer_load_dwordx4 v10, s[60:63], s91 offen offset:2048 sc1 lds
    buffer_load_dwordx4 v11, s[60:63], s91 offen offset:3072 sc1 lds
    s_add_u32 m0, s89, 90112
    s_nop 0
    buffer_load_dwordx4 v12, s[60:63], s91 offen sc1 lds
    s_add_u32 s13, s13, 1
    s_and_b32 s13, s13, 15
    s_lshr_b32 s78, s13, 3
    s_mul_i32 s78, s78, 2621440
    s_and_b32 s91, s13, 7
    s_mul_i32 s91, s91, 20480
    s_add_u32 s91, s91, s78
    s_add_u32 m0, s89, 106496
    s_nop 0
    buffer_load_dwordx4 v8, s[60:63], s91 offen sc1 lds
    buffer_load_dwordx4 v9, s[60:63], s91 offen offset:1024 sc1 lds
    buffer_load_dwordx4 v10, s[60:63], s91 offen offset:2048 sc1 lds
    buffer_load_dwordx4 v11, s[60:63], s91 offen offset:3072 sc1 lds
    s_add_u32 m0, s89, 110592
    s_nop 0
    buffer_load_dwordx4 v12, s[60:63], s91 offen sc1 lds
    s_add_u32 s13, s13, 1
    s_and_b32 s13, s13, 15
    s_waitcnt vmcnt(5)
    s_barrier
    s_lshr_b32 s78, s13, 3
    s_mul_i32 s78, s78, 2621440
    s_and_b32 s91, s13, 7
    s_mul_i32 s91, s91, 20480
    s_add_u32 s91, s91, s78
    s_add_u32 m0, s89, 126976
    s_nop 0
    buffer_load_dwordx4 v8, s[60:63], s91 offen sc1 lds
    buffer_load_dwordx4 v9, s[60:63], s91 offen offset:1024 sc1 lds
    buffer_load_dwordx4 v10, s[60:63], s91 offen offset:2048 sc1 lds
    buffer_load_dwordx4 v11, s[60:63], s91 offen offset:3072 sc1 lds
    s_add_u32 m0, s89, 131072
    s_nop 0
    buffer_load_dwordx4 v12, s[60:63], s91 offen sc1 lds
    s_add_u32 s13, s13, 1
    s_and_b32 s13, s13, 15
    s_cmp_lt_u32 s12, 8
    s_cselect_b32 s8, s36, s40
    s_cselect_b32 s9, s37, s41
    s_and_b32 s90, s12, 7
    s_lshl_b32 s90, s90, 7
    s_add_u32 m0, s88, 32768
    s_nop 0
    buffer_load_dwordx4 v4, s[8:11], s90 offen lds
    buffer_load_dwordx4 v5, s[8:11], s90 offen offset:1024 lds
    buffer_load_dwordx4 v6, s[8:11], s90 offen offset:2048 lds
    buffer_load_dwordx4 v7, s[8:11], s90 offen offset:3072 lds
    s_add_u32 s12, s12, 1
    s_and_b32 s12, s12, 15
    s_lshr_b32 s78, s13, 3
    s_mul_i32 s78, s78, 2621440
    s_and_b32 s91, s13, 7
    s_mul_i32 s91, s91, 20480
    s_add_u32 s91, s91, s78
    s_add_u32 m0, s89, 65536
    s_nop 0
    buffer_load_dwordx4 v8, s[60:63], s91 offen sc1 lds
    buffer_load_dwordx4 v9, s[60:63], s91 offen offset:1024 sc1 lds
    buffer_load_dwordx4 v10, s[60:63], s91 offen offset:2048 sc1 lds
    buffer_load_dwordx4 v11, s[60:63], s91 offen offset:3072 sc1 lds
    s_add_u32 m0, s89, 69632
    s_nop 0
    buffer_load_dwordx4 v12, s[60:63], s91 offen sc1 lds
    s_add_u32 s13, s13, 1
    s_and_b32 s13, s13, 15
    s_waitcnt vmcnt(14)
    s_barrier
    s_cmp_lt_u32 s12, 8
    s_cselect_b32 s8, s36, s40
    s_cselect_b32 s9, s37, s41
    s_and_b32 s90, s12, 7
    s_lshl_b32 s90, s90, 7
    s_add_u32 m0, s88, 49152
    s_nop 0
    buffer_load_dwordx4 v4, s[8:11], s90 offen lds
    buffer_load_dwordx4 v5, s[8:11], s90 offen offset:1024 lds
    buffer_load_dwordx4 v6, s[8:11], s90 offen offset:2048 lds
    buffer_load_dwordx4 v7, s[8:11], s90 offen offset:3072 lds
    s_add_u32 s12, s12, 1
    s_and_b32 s12, s12, 15
    s_lshr_b32 s78, s13, 3
    s_mul_i32 s78, s78, 2621440
    s_and_b32 s91, s13, 7
    s_mul_i32 s91, s91, 20480
    s_add_u32 s91, s91, s78
    s_add_u32 m0, s89, 86016
    s_nop 0
    buffer_load_dwordx4 v8, s[60:63], s91 offen sc1 lds
    buffer_load_dwordx4 v9, s[60:63], s91 offen offset:1024 sc1 lds
    buffer_load_dwordx4 v10, s[60:63], s91 offen offset:2048 sc1 lds
    buffer_load_dwordx4 v11, s[60:63], s91 offen offset:3072 sc1 lds
    s_add_u32 m0, s89, 90112
    s_nop 0
    buffer_load_dwordx4 v12, s[60:63], s91 offen sc1 lds
    s_add_u32 s13, s13, 1
    s_and_b32 s13, s13, 15
    s_waitcnt vmcnt(18)
    s_barrier
    s_cmp_lt_u32 s12, 8
    s_cselect_b32 s8, s36, s40
    s_cselect_b32 s9, s37, s41
    s_and_b32 s90, s12, 7
    s_lshl_b32 s90, s90, 7
    s_add_u32 m0, s88, 0
    s_nop 0
    buffer_load_dwordx4 v4, s[8:11], s90 offen lds
    buffer_load_dwordx4 v5, s[8:11], s90 offen offset:1024 lds
    buffer_load_dwordx4 v6, s[8:11], s90 offen offset:2048 lds
    buffer_load_dwordx4 v7, s[8:11], s90 offen offset:3072 lds
    s_add_u32 s12, s12, 1
    s_and_b32 s12, s12, 15
    s_lshr_b32 s78, s13, 3
    s_mul_i32 s78, s78, 2621440
    s_and_b32 s91, s13, 7
    s_mul_i32 s91, s91, 20480
    s_add_u32 s91, s91, s78
    s_add_u32 m0, s89, 106496
    s_nop 0
    buffer_load_dwordx4 v8, s[60:63], s91 offen sc1 lds
    buffer_load_dwordx4 v9, s[60:63], s91 offen offset:1024 sc1 lds
    buffer_load_dwordx4 v10, s[60:63], s91 offen offset:2048 sc1 lds
    buffer_load_dwordx4 v11, s[60:63], s91 offen offset:3072 sc1 lds
    s_add_u32 m0, s89, 110592
    s_nop 0
    buffer_load_dwordx4 v12, s[60:63], s91 offen sc1 lds
    s_add_u32 s13, s13, 1
    s_and_b32 s13, s13, 15
    s_waitcnt vmcnt(18)
    s_barrier
    s_cmp_lt_u32 s12, 8
    s_cselect_b32 s8, s36, s40
    s_cselect_b32 s9, s37, s41
    s_and_b32 s90, s12, 7
    s_lshl_b32 s90, s90, 7
    s_add_u32 m0, s88, 16384
    s_nop 0
    buffer_load_dwordx4 v4, s[8:11], s90 offen lds
    buffer_load_dwordx4 v5, s[8:11], s90 offen offset:1024 lds
    buffer_load_dwordx4 v6, s[8:11], s90 offen offset:2048 lds
    buffer_load_dwordx4 v7, s[8:11], s90 offen offset:3072 lds
    s_add_u32 s12, s12, 1
    s_and_b32 s12, s12, 15
    s_lshr_b32 s78, s13, 3
    s_mul_i32 s78, s78, 2621440
    s_and_b32 s91, s13, 7
    s_mul_i32 s91, s91, 20480
    s_add_u32 s91, s91, s78
    s_add_u32 m0, s89, 126976
    s_nop 0
    buffer_load_dwordx4 v8, s[60:63], s91 offen sc1 lds
    buffer_load_dwordx4 v9, s[60:63], s91 offen offset:1024 sc1 lds
    buffer_load_dwordx4 v10, s[60:63], s91 offen offset:2048 sc1 lds
    buffer_load_dwordx4 v11, s[60:63], s91 offen offset:3072 sc1 lds
    s_add_u32 m0, s89, 131072
    s_nop 0
    buffer_load_dwordx4 v12, s[60:63], s91 offen sc1 lds
    s_add_u32 s13, s13, 1
    s_and_b32 s13, s13, 15
    s_waitcnt vmcnt(18)
    s_barrier
    s_cmp_lt_u32 s12, 8
    s_cselect_b32 s8, s36, s40
    s_cselect_b32 s9, s37, s41
    s_and_b32 s90, s12, 7
    s_lshl_b32 s90, s90, 7
    s_add_u32 m0, s88, 32768
    s_nop 0
    buffer_load_dwordx4 v4, s[8:11], s90 offen lds
    buffer_load_dwordx4 v5, s[8:11], s90 offen offset:1024 lds
    buffer_load_dwordx4 v6, s[8:11], s90 offen offset:2048 lds
    buffer_load_dwordx4 v7, s[8:11], s90 offen offset:3072 lds
    s_add_u32 s12, s12, 1
    s_and_b32 s12, s12, 15
    s_lshr_b32 s78, s13, 3
    s_mul_i32 s78, s78, 2621440
    s_and_b32 s91, s13, 7
    s_mul_i32 s91, s91, 20480
    s_add_u32 s91, s91, s78
    s_add_u32 m0, s89, 65536
    s_nop 0
    buffer_load_dwordx4 v8, s[60:63], s91 offen sc1 lds
    buffer_load_dwordx4 v9, s[60:63], s91 offen offset:1024 sc1 lds
    buffer_load_dwordx4 v10, s[60:63], s91 offen offset:2048 sc1 lds
    buffer_load_dwordx4 v11, s[60:63], s91 offen offset:3072 sc1 lds
    s_add_u32 m0, s89, 69632
    s_nop 0
    buffer_load_dwordx4 v12, s[60:63], s91 offen sc1 lds
    s_add_u32 s13, s13, 1
    s_and_b32 s13, s13, 15
    s_waitcnt vmcnt(18)
    s_barrier
    s_cmp_lt_u32 s12, 8
    s_cselect_b32 s8, s36, s40
    s_cselect_b32 s9, s37, s41
    s_and_b32 s90, s12, 7
    s_lshl_b32 s90, s90, 7
    s_add_u32 m0, s88, 49152
    s_nop 0
    buffer_load_dwordx4 v4, s[8:11], s90 offen lds
    buffer_load_dwordx4 v5, s[8:11], s90 offen offset:1024 lds
    buffer_load_dwordx4 v6, s[8:11], s90 offen offset:2048 lds
    buffer_load_dwordx4 v7, s[8:11], s90 offen offset:3072 lds
    s_add_u32 s12, s12, 1
    s_and_b32 s12, s12, 15
    s_lshr_b32 s78, s13, 3
    s_mul_i32 s78, s78, 2621440
    s_and_b32 s91, s13, 7
    s_mul_i32 s91, s91, 20480
    s_add_u32 s91, s91, s78
    s_add_u32 m0, s89, 86016
    s_nop 0
    buffer_load_dwordx4 v8, s[60:63], s91 offen sc1 lds
    buffer_load_dwordx4 v9, s[60:63], s91 offen offset:1024 sc1 lds
    buffer_load_dwordx4 v10, s[60:63], s91 offen offset:2048 sc1 lds
    buffer_load_dwordx4 v11, s[60:63], s91 offen offset:3072 sc1 lds
    s_add_u32 m0, s89, 90112
    s_nop 0
    buffer_load_dwordx4 v12, s[60:63], s91 offen sc1 lds
    s_add_u32 s13, s13, 1
    s_and_b32 s13, s13, 15
    s_waitcnt vmcnt(18)
    s_barrier
    s_cmp_lt_u32 s12, 8
    s_cselect_b32 s8, s36, s40
    s_cselect_b32 s9, s37, s41
    s_and_b32 s90, s12, 7
    s_lshl_b32 s90, s90, 7
    s_add_u32 m0, s88, 0
    s_nop 0
    buffer_load_dwordx4 v4, s[8:11], s90 offen lds
    buffer_load_dwordx4 v5, s[8:11], s90 offen offset:1024 lds
    buffer_load_dwordx4 v6, s[8:11], s90 offen offset:2048 lds
    buffer_load_dwordx4 v7, s[8:11], s90 offen offset:3072 lds
    s_add_u32 s12, s12, 1
    s_and_b32 s12, s12, 15
    s_lshr_b32 s78, s13, 3
    s_mul_i32 s78, s78, 2621440
    s_and_b32 s91, s13, 7
    s_mul_i32 s91, s91, 20480
    s_add_u32 s91, s91, s78
    s_add_u32 m0, s89, 106496
    s_nop 0
    buffer_load_dwordx4 v8, s[60:63], s91 offen sc1 lds
    buffer_load_dwordx4 v9, s[60:63], s91 offen offset:1024 sc1 lds
    buffer_load_dwordx4 v10, s[60:63], s91 offen offset:2048 sc1 lds
    buffer_load_dwordx4 v11, s[60:63], s91 offen offset:3072 sc1 lds
    s_add_u32 m0, s89, 110592
    s_nop 0
    buffer_load_dwordx4 v12, s[60:63], s91 offen sc1 lds
    s_add_u32 s13, s13, 1
    s_and_b32 s13, s13, 15
    s_waitcnt vmcnt(18)
    s_barrier
    s_cmp_lt_u32 s12, 8
    s_cselect_b32 s8, s36, s40
    s_cselect_b32 s9, s37, s41
    s_and_b32 s90, s12, 7
    s_lshl_b32 s90, s90, 7
    s_add_u32 m0, s88, 16384
    s_nop 0
    buffer_load_dwordx4 v4, s[8:11], s90 offen lds
    buffer_load_dwordx4 v5, s[8:11], s90 offen offset:1024 lds
    buffer_load_dwordx4 v6, s[8:11], s90 offen offset:2048 lds
    buffer_load_dwordx4 v7, s[8:11], s90 offen offset:3072 lds
    s_add_u32 s12, s12, 1
    s_and_b32 s12, s12, 15
    s_lshr_b32 s78, s13, 3
    s_mul_i32 s78, s78, 2621440
    s_and_b32 s91, s13, 7
    s_mul_i32 s91, s91, 20480
    s_add_u32 s91, s91, s78
    s_add_u32 m0, s89, 126976
    s_nop 0
    buffer_load_dwordx4 v8, s[60:63], s91 offen sc1 lds
    buffer_load_dwordx4 v9, s[60:63], s91 offen offset:1024 sc1 lds
    buffer_load_dwordx4 v10, s[60:63], s91 offen offset:2048 sc1 lds
    buffer_load_dwordx4 v11, s[60:63], s91 offen offset:3072 sc1 lds
    s_add_u32 m0, s89, 131072
    s_nop 0
    buffer_load_dwordx4 v12, s[60:63], s91 offen sc1 lds
    s_add_u32 s13, s13, 1
    s_and_b32 s13, s13, 15
    s_waitcnt vmcnt(18)
    s_barrier
    s_cmp_lt_u32 s12, 8
    s_cselect_b32 s8, s36, s40
    s_cselect_b32 s9, s37, s41
    s_and_b32 s90, s12, 7
    s_lshl_b32 s90, s90, 7
    s_add_u32 m0, s88, 32768
    s_nop 0
    buffer_load_dwordx4 v4, s[8:11], s90 offen lds
    buffer_load_dwordx4 v5, s[8:11], s90 offen offset:1024 lds
    buffer_load_dwordx4 v6, s[8:11], s90 offen offset:2048 lds
    buffer_load_dwordx4 v7, s[8:11], s90 offen offset:3072 lds
    s_add_u32 s12, s12, 1
    s_and_b32 s12, s12, 15
    s_lshr_b32 s78, s13, 3
    s_mul_i32 s78, s78, 2621440
    s_and_b32 s91, s13, 7
    s_mul_i32 s91, s91, 20480
    s_add_u32 s91, s91, s78
    s_add_u32 m0, s89, 65536
    s_nop 0
    buffer_load_dwordx4 v8, s[60:63], s91 offen sc1 lds
    buffer_load_dwordx4 v9, s[60:63], s91 offen offset:1024 sc1 lds
    buffer_load_dwordx4 v10, s[60:63], s91 offen offset:2048 sc1 lds
    buffer_load_dwordx4 v11, s[60:63], s91 offen offset:3072 sc1 lds
    s_add_u32 m0, s89, 69632
    s_nop 0
    buffer_load_dwordx4 v12, s[60:63], s91 offen sc1 lds
    s_add_u32 s13, s13, 1
    s_and_b32 s13, s13, 15
    s_waitcnt vmcnt(18)
    s_barrier
    s_cmp_lt_u32 s12, 8
    s_cselect_b32 s8, s36, s40
    s_cselect_b32 s9, s37, s41
    s_and_b32 s90, s12, 7
    s_lshl_b32 s90, s90, 7
    s_add_u32 m0, s88, 49152
    s_nop 0
    buffer_load_dwordx4 v4, s[8:11], s90 offen lds
    buffer_load_dwordx4 v5, s[8:11], s90 offen offset:1024 lds
    buffer_load_dwordx4 v6, s[8:11], s90 offen offset:2048 lds
    buffer_load_dwordx4 v7, s[8:11], s90 offen offset:3072 lds
    s_add_u32 s12, s12, 1
    s_and_b32 s12, s12, 15
    s_lshr_b32 s78, s13, 3
    s_mul_i32 s78, s78, 2621440
    s_and_b32 s91, s13, 7
    s_mul_i32 s91, s91, 20480
    s_add_u32 s91, s91, s78
    s_add_u32 m0, s89, 86016
    s_nop 0
    buffer_load_dwordx4 v8, s[60:63], s91 offen sc1 lds
    buffer_load_dwordx4 v9, s[60:63], s91 offen offset:1024 sc1 lds
    buffer_load_dwordx4 v10, s[60:63], s91 offen offset:2048 sc1 lds
    buffer_load_dwordx4 v11, s[60:63], s91 offen offset:3072 sc1 lds
    s_add_u32 m0, s89, 90112
    s_nop 0
    buffer_load_dwordx4 v12, s[60:63], s91 offen sc1 lds
    s_add_u32 s13, s13, 1
    s_and_b32 s13, s13, 15
    s_andn2_b32 s78, s2, 0x18
    v_and_b32 v16, 3, v0
    v_lshlrev_b32 v17, 3, v16
    v_add_u32 v17, s78, v17
    v_xor_b32 v18, s2, v16
    v_and_b32 v19, 4, v0
    v_cmp_eq_u32 vcc, 0, v19
    s_nop 1
    v_cndmask_b32 v64, v18, v17, vcc
    v_lshlrev_b32 v64, 7, v64
    v_add_u32 v64, 32505872, v64
    buffer_load_dwordx4 v[72:75], v64, s[60:63], 0 offen sc1
    s_waitcnt vmcnt(19)
    s_barrier
    s_cmp_lt_u32 s12, 8
    s_cselect_b32 s8, s36, s40
    s_cselect_b32 s9, s37, s41
    s_and_b32 s90, s12, 7
    s_lshl_b32 s90, s90, 7
    s_add_u32 m0, s88, 0
    s_nop 0
    buffer_load_dwordx4 v4, s[8:11], s90 offen lds
    buffer_load_dwordx4 v5, s[8:11], s90 offen offset:1024 lds
    buffer_load_dwordx4 v6, s[8:11], s90 offen offset:2048 lds
    buffer_load_dwordx4 v7, s[8:11], s90 offen offset:3072 lds
    s_add_u32 s12, s12, 1
    s_and_b32 s12, s12, 15
    s_lshr_b32 s78, s13, 3
    s_mul_i32 s78, s78, 2621440
    s_and_b32 s91, s13, 7
    s_mul_i32 s91, s91, 20480
    s_add_u32 s91, s91, s78
    s_add_u32 m0, s89, 106496
    s_nop 0
    buffer_load_dwordx4 v8, s[60:63], s91 offen sc1 lds
    buffer_load_dwordx4 v9, s[60:63], s91 offen offset:1024 sc1 lds
    buffer_load_dwordx4 v10, s[60:63], s91 offen offset:2048 sc1 lds
    buffer_load_dwordx4 v11, s[60:63], s91 offen offset:3072 sc1 lds
    s_add_u32 m0, s89, 110592
    s_nop 0
    buffer_load_dwordx4 v12, s[60:63], s91 offen sc1 lds
    s_add_u32 s13, s13, 1
    s_and_b32 s13, s13, 15
    s_waitcnt vmcnt(19)
    s_barrier
    s_cmp_lt_u32 s12, 8
    s_cselect_b32 s8, s36, s40
    s_cselect_b32 s9, s37, s41
    s_and_b32 s90, s12, 7
    s_lshl_b32 s90, s90, 7
    s_add_u32 m0, s88, 16384
    s_nop 0
    buffer_load_dwordx4 v4, s[8:11], s90 offen lds
    buffer_load_dwordx4 v5, s[8:11], s90 offen offset:1024 lds
    buffer_load_dwordx4 v6, s[8:11], s90 offen offset:2048 lds
    buffer_load_dwordx4 v7, s[8:11], s90 offen offset:3072 lds
    s_add_u32 s12, s12, 1
    s_and_b32 s12, s12, 15
    s_lshr_b32 s78, s13, 3
    s_mul_i32 s78, s78, 2621440
    s_and_b32 s91, s13, 7
    s_mul_i32 s91, s91, 20480
    s_add_u32 s91, s91, s78
    s_add_u32 m0, s89, 126976
    s_nop 0
    buffer_load_dwordx4 v8, s[60:63], s91 offen sc1 lds
    buffer_load_dwordx4 v9, s[60:63], s91 offen offset:1024 sc1 lds
    buffer_load_dwordx4 v10, s[60:63], s91 offen offset:2048 sc1 lds
    buffer_load_dwordx4 v11, s[60:63], s91 offen offset:3072 sc1 lds
    s_add_u32 m0, s89, 131072
    s_nop 0
    buffer_load_dwordx4 v12, s[60:63], s91 offen sc1 lds
    s_add_u32 s13, s13, 1
    s_and_b32 s13, s13, 15
    s_waitcnt vmcnt(19)
    s_barrier
    s_mul_i32 s78, s73, 48
    s_mul_i32 s79, s72, 12
    s_add_u32 s78, s78, s79
    s_lshl_b32 s78, s78, 13
    s_add_u32 s78, s78, 5242880
    s_lshl_b32 s79, s87, 12
    s_add_u32 s78, s78, s79
    v_lshlrev_b32 v16, 4, v0
    s_xor_b32 s79, s72, 0
    s_lshl_b32 s79, s79, 10
    s_add_u32 s79, s79, s78
    s_sub_u32 s79, s79, 0
    v_add_u32 v4, s79, v16
    s_xor_b32 s79, s72, 1
    s_lshl_b32 s79, s79, 10
    s_add_u32 s79, s79, s78
    s_sub_u32 s79, s79, 1024
    v_add_u32 v5, s79, v16
    s_xor_b32 s79, s72, 2
    s_lshl_b32 s79, s79, 10
    s_add_u32 s79, s79, s78
    s_sub_u32 s79, s79, 2048
    v_add_u32 v6, s79, v16
    s_xor_b32 s79, s72, 3
    s_lshl_b32 s79, s79, 10
    s_add_u32 s79, s79, s78
    s_sub_u32 s79, s79, 3072
    v_add_u32 v7, s79, v16
    s_and_b32 s15, s73, 7
    s_mul_i32 s15, s15, 3
    s_lshr_b32 s15, s15, 2
    s_mul_i32 s78, s74, 3
    s_lshr_b32 s78, s78, 1
    s_add_u32 s15, s15, s78
    s_sub_u32 s78, s15, 6
    s_cmp_ge_u32 s15, 6
    s_cselect_b32 s15, s78, s15
    s_mul_i32 s90, s15, 16384
    s_waitcnt vmcnt(18)
    v_and_b32 v72, v72, v73
    v_and_b32 v74, v74, v75
    v_and_b32 v72, v72, v74
    v_cmp_ne_u32 vcc, 1, v72
    s_cbranch_vccz Lok_32
    s_mov_b32 s92, 0x20000
Lpoll_33:
    buffer_load_dwordx4 v[72:75], v64, s[60:63], 0 offen sc1
    s_waitcnt vmcnt(0)
    v_and_b32 v72, v72, v73
    v_and_b32 v74, v74, v75
    v_and_b32 v72, v72, v74
    v_cmp_ne_u32 vcc, 1, v72
    s_cbranch_vccz Lpd_34
    s_sleep 8
    s_sub_u32 s92, s92, 1
    s_cmp_lg_u32 s92, 0
    s_cbranch_scc1 Lpoll_33
Lpd_34:
Lok_32:
    s_add_u32 m0, s88, 32768
    s_nop 0
    buffer_load_dwordx4 v4, s[60:63], s90 offen sc1 lds
    buffer_load_dwordx4 v5, s[60:63], s90 offen offset:1024 sc1 lds
    buffer_load_dwordx4 v6, s[60:63], s90 offen offset:2048 sc1 lds
    buffer_load_dwordx4 v7, s[60:63], s90 offen offset:3072 sc1 lds
    s_add_u32 s90, s90, 16384
    s_cmp_eq_u32 s90, 98304
    s_cselect_b32 s90, 0, s90
    s_mul_i32 s78, s72, 491520
    s_mul_i32 s79, s74, 320
    s_add_u32 s78, s78, s79
    s_mul_i32 s79, s87, 80
    v_lshrrev_b32 v16, 2, v0
    v_add_u32 v16, s79, v16
    v_and_b32 v17, 3, v0
    v_add_u32 v18, 0, v16
    v_mul_u32_u24 v19, 52429, v18
    v_lshrrev_b32 v19, 18, v19
    v_mul_u32_u24 v20, 5, v19
    v_sub_u32 v20, v18, v20
    v_lshrrev_b32 v21, 1, v19
    v_and_b32 v21, 2, v21
    v_xor_b32 v21, v21, v17
    v_mul_u32_u24 v19, 1280, v19
    v_lshl_add_u32 v19, v20, 6, v19
    v_lshl_add_u32 v19, v21, 4, v19
    v_add_u32 v19, s78, v19
    v_subrev_u32 v8, 0, v19
    v_add_u32 v18, 16, v16
    v_mul_u32_u24 v19, 52429, v18
    v_lshrrev_b32 v19, 18, v19
    v_mul_u32_u24 v20, 5, v19
    v_sub_u32 v20, v18, v20
    v_lshrrev_b32 v21, 1, v19
    v_and_b32 v21, 2, v21
    v_xor_b32 v21, v21, v17
    v_mul_u32_u24 v19, 1280, v19
    v_lshl_add_u32 v19, v20, 6, v19
    v_lshl_add_u32 v19, v21, 4, v19
    v_add_u32 v19, s78, v19
    v_subrev_u32 v9, 1024, v19
    v_add_u32 v18, 32, v16
    v_mul_u32_u24 v19, 52429, v18
    v_lshrrev_b32 v19, 18, v19
    v_mul_u32_u24 v20, 5, v19
    v_sub_u32 v20, v18, v20
    v_lshrrev_b32 v21, 1, v19
    v_and_b32 v21, 2, v21
    v_xor_b32 v21, v21, v17
    v_mul_u32_u24 v19, 1280, v19
    v_lshl_add_u32 v19, v20, 6, v19
    v_lshl_add_u32 v19, v21, 4, v19
    v_add_u32 v19, s78, v19
    v_subrev_u32 v10, 2048, v19
    v_add_u32 v18, 48, v16
    v_mul_u32_u24 v19, 52429, v18
    v_lshrrev_b32 v19, 18, v19
    v_mul_u32_u24 v20, 5, v19
    v_sub_u32 v20, v18, v20
    v_lshrrev_b32 v21, 1, v19
    v_and_b32 v21, 2, v21
    v_xor_b32 v21, v21, v17
    v_mul_u32_u24 v19, 1280, v19
    v_lshl_add_u32 v19, v20, 6, v19
    v_lshl_add_u32 v19, v21, 4, v19
    v_add_u32 v19, s78, v19
    v_subrev_u32 v11, 3072, v19
    v_add_u32 v18, 64, v16
    v_mul_u32_u24 v19, 52429, v18
    v_lshrrev_b32 v19, 18, v19
    v_mul_u32_u24 v20, 5, v19
    v_sub_u32 v20, v18, v20
    v_lshrrev_b32 v21, 1, v19
    v_and_b32 v21, 2, v21
    v_xor_b32 v21, v21, v17
    v_mul_u32_u24 v19, 1280, v19
    v_lshl_add_u32 v19, v20, 6, v19
    v_lshl_add_u32 v19, v21, 4, v19
    v_add_u32 v19, s78, v19
    v_subrev_u32 v12, 0, v19
    s_mul_i32 s89, s87, 5120
    s_and_b32 s15, s73, 7
    s_mul_i32 s15, s15, 3
    s_lshr_b32 s15, s15, 2
    s_mul_i32 s78, s74, 3
    s_lshr_b32 s78, s78, 1
    s_add_u32 s15, s15, s78
    s_sub_u32 s78, s15, 6
    s_cmp_ge_u32 s15, 6
    s_cselect_b32 s15, s78, s15
    s_mul_i32 s91, s15, 81920
    s_add_u32 m0, s89, 65536
    s_nop 0
    buffer_load_dwordx4 v8, s[52:55], s91 offen lds
    buffer_load_dwordx4 v9, s[52:55], s91 offen offset:1024 lds
    buffer_load_dwordx4 v10, s[52:55], s91 offen offset:2048 lds
    buffer_load_dwordx4 v11, s[52:55], s91 offen offset:3072 lds
    s_add_u32 m0, s89, 69632
    s_nop 0
    buffer_load_dwordx4 v12, s[52:55], s91 offen lds
    s_add_u32 s91, s91, 81920
    s_cmp_eq_u32 s91, 491520
    s_cselect_b32 s91, 0, s91
    s_waitcnt vmcnt(18)
    s_barrier
    s_add_u32 m0, s88, 49152
    s_nop 0
    buffer_load_dwordx4 v4, s[60:63], s90 offen sc1 lds
    buffer_load_dwordx4 v5, s[60:63], s90 offen offset:1024 sc1 lds
    buffer_load_dwordx4 v6, s[60:63], s90 offen offset:2048 sc1 lds
    buffer_load_dwordx4 v7, s[60:63], s90 offen offset:3072 sc1 lds
    s_add_u32 s90, s90, 16384
    s_cmp_eq_u32 s90, 98304
    s_cselect_b32 s90, 0, s90
    s_add_u32 m0, s89, 86016
    s_nop 0
    buffer_load_dwordx4 v8, s[52:55], s91 offen lds
    buffer_load_dwordx4 v9, s[52:55], s91 offen offset:1024 lds
    buffer_load_dwordx4 v10, s[52:55], s91 offen offset:2048 lds
    buffer_load_dwordx4 v11, s[52:55], s91 offen offset:3072 lds
    s_add_u32 m0, s89, 90112
    s_nop 0
    buffer_load_dwordx4 v12, s[52:55], s91 offen lds
    s_add_u32 s91, s91, 81920
    s_cmp_eq_u32 s91, 491520
    s_cselect_b32 s91, 0, s91
    s_waitcnt vmcnt(18)
    s_barrier
    s_add_u32 m0, s88, 0
    s_nop 0
    buffer_load_dwordx4 v4, s[60:63], s90 offen sc1 lds
    buffer_load_dwordx4 v5, s[60:63], s90 offen offset:1024 sc1 lds
    buffer_load_dwordx4 v6, s[60:63], s90 offen offset:2048 sc1 lds
    buffer_load_dwordx4 v7, s[60:63], s90 offen offset:3072 sc1 lds
    s_add_u32 s90, s90, 16384
    s_cmp_eq_u32 s90, 98304
    s_cselect_b32 s90, 0, s90
    s_add_u32 m0, s89, 106496
    s_nop 0
    buffer_load_dwordx4 v8, s[52:55], s91 offen lds
    buffer_load_dwordx4 v9, s[52:55], s91 offen offset:1024 lds
    buffer_load_dwordx4 v10, s[52:55], s91 offen offset:2048 lds
    buffer_load_dwordx4 v11, s[52:55], s91 offen offset:3072 lds
    s_add_u32 m0, s89, 110592
    s_nop 0
    buffer_load_dwordx4 v12, s[52:55], s91 offen lds
    s_add_u32 s91, s91, 81920
    s_cmp_eq_u32 s91, 491520
    s_cselect_b32 s91, 0, s91
    s_barrier
    s_add_u32 m0, s88, 16384
    s_nop 0
    buffer_load_dwordx4 v4, s[60:63], s90 offen sc1 lds
    buffer_load_dwordx4 v5, s[60:63], s90 offen offset:1024 sc1 lds
    buffer_load_dwordx4 v6, s[60:63], s90 offen offset:2048 sc1 lds
    buffer_load_dwordx4 v7, s[60:63], s90 offen offset:3072 sc1 lds
    s_add_u32 s90, s90, 16384
    s_cmp_eq_u32 s90, 98304
    s_cselect_b32 s90, 0, s90
    s_add_u32 m0, s89, 126976
    s_nop 0
    buffer_load_dwordx4 v8, s[52:55], s91 offen lds
    buffer_load_dwordx4 v9, s[52:55], s91 offen offset:1024 lds
    buffer_load_dwordx4 v10, s[52:55], s91 offen offset:2048 lds
    buffer_load_dwordx4 v11, s[52:55], s91 offen offset:3072 lds
    s_add_u32 m0, s89, 131072
    s_nop 0
    buffer_load_dwordx4 v12, s[52:55], s91 offen lds
    s_add_u32 s91, s91, 81920
    s_cmp_eq_u32 s91, 491520
    s_cselect_b32 s91, 0, s91
    s_waitcnt vmcnt(27)
    s_barrier
    s_waitcnt vmcnt(18)
    s_barrier
    s_add_u32 m0, s88, 32768
    s_nop 0
    buffer_load_dwordx4 v4, s[60:63], s90 offen sc1 lds
    buffer_load_dwordx4 v5, s[60:63], s90 offen offset:1024 sc1 lds
    buffer_load_dwordx4 v6, s[60:63], s90 offen offset:2048 sc1 lds
    buffer_load_dwordx4 v7, s[60:63], s90 offen offset:3072 sc1 lds
    s_add_u32 s90, s90, 16384
    s_cmp_eq_u32 s90, 98304
    s_cselect_b32 s90, 0, s90
    s_add_u32 m0, s89, 65536
    s_nop 0
    buffer_load_dwordx4 v8, s[52:55], s91 offen lds
    buffer_load_dwordx4 v9, s[52:55], s91 offen offset:1024 lds
    buffer_load_dwordx4 v10, s[52:55], s91 offen offset:2048 lds
    buffer_load_dwordx4 v11, s[52:55], s91 offen offset:3072 lds
    s_add_u32 m0, s89, 69632
    s_nop 0
    buffer_load_dwordx4 v12, s[52:55], s91 offen lds
    s_add_u32 s91, s91, 81920
    s_cmp_eq_u32 s91, 491520
    s_cselect_b32 s91, 0, s91
    s_waitcnt vmcnt(18)
    s_barrier
    s_add_u32 m0, s88, 49152
    s_nop 0
    buffer_load_dwordx4 v4, s[60:63], s90 offen sc1 lds
    buffer_load_dwordx4 v5, s[60:63], s90 offen offset:1024 sc1 lds
    buffer_load_dwordx4 v6, s[60:63], s90 offen offset:2048 sc1 lds
    buffer_load_dwordx4 v7, s[60:63], s90 offen offset:3072 sc1 lds
    s_add_u32 s90, s90, 16384
    s_cmp_eq_u32 s90, 98304
    s_cselect_b32 s90, 0, s90
    s_add_u32 m0, s89, 86016
    s_nop 0
    buffer_load_dwordx4 v8, s[52:55], s91 offen lds
    buffer_load_dwordx4 v9, s[52:55], s91 offen offset:1024 lds
    buffer_load_dwordx4 v10, s[52:55], s91 offen offset:2048 lds
    buffer_load_dwordx4 v11, s[52:55], s91 offen offset:3072 lds
    s_add_u32 m0, s89, 90112
    s_nop 0
    buffer_load_dwordx4 v12, s[52:55], s91 offen lds
    s_add_u32 s91, s91, 81920
    s_cmp_eq_u32 s91, 491520
    s_cselect_b32 s91, 0, s91
    s_waitcnt vmcnt(18)
    s_barrier
    s_waitcnt vmcnt(9)
    s_barrier
    s_waitcnt vmcnt(0)
    s_barrier
    s_barrier
    s_waitcnt vmcnt(0)
    s_endpgm
L_loader_Y:
    s_lshl_b32 s78, s73, 7
    s_lshl_b32 s79, s87, 5
    s_add_u32 s78, s78, s79
    v_add_u32 v16, s78, v1
    v_mul_u32_u24 v16, 1280, v16
    v_lshrrev_b32 v17, 1, v1
    v_and_b32 v18, 1, v17
    v_mul_u32_u24 v18, 3, v18
    v_or_b32 v18, 0, v18
    v_xor_b32 v18, v18, v2
    v_lshl_add_u32 v18, v18, 4, v16
    v_add_u32 v4, 0, v18
    v_and_b32 v18, 1, v17
    v_mul_u32_u24 v18, 3, v18
    v_or_b32 v18, 4, v18
    v_xor_b32 v18, v18, v2
    v_lshl_add_u32 v18, v18, 4, v16
    v_add_u32 v5, 9216, v18
    v_and_b32 v18, 1, v17
    v_mul_u32_u24 v18, 3, v18
    v_or_b32 v18, 0, v18
    v_xor_b32 v18, v18, v2
    v_lshl_add_u32 v18, v18, 4, v16
    v_add_u32 v6, 18432, v18
    v_and_b32 v18, 1, v17
    v_mul_u32_u24 v18, 3, v18
    v_or_b32 v18, 4, v18
    v_xor_b32 v18, v18, v2
    v_lshl_add_u32 v18, v18, 4, v16
    v_add_u32 v7, 27648, v18
    s_and_b32 s15, s73, 7
    s_mul_i32 s15, s15, 5
    s_lshr_b32 s15, s15, 2
    s_and_b32 s78, s74, 1
    s_mul_i32 s78, s78, 5
    s_add_u32 s15, s15, s78
    s_and_b32 s78, s74, 2
    s_add_u32 s15, s15, s78
    s_sub_u32 s78, s15, 10
    s_cmp_ge_u32 s15, 10
    s_cselect_b32 s15, s78, s15
    s_mul_i32 s90, s15, 128
    s_add_u32 m0, s88, 0
    s_nop 0
    buffer_load_dwordx4 v4, s[32:35], s90 offen lds
    buffer_load_dwordx4 v5, s[32:35], s90 offen offset:1024 lds
    buffer_load_dwordx4 v6, s[32:35], s90 offen offset:2048 lds
    buffer_load_dwordx4 v7, s[32:35], s90 offen offset:3072 lds
    s_add_u32 s90, s90, 128
    s_cmp_eq_u32 s90, 1280
    s_cselect_b32 s90, 0, s90
    s_and_b32 s78, s98, 3
    s_mul_i32 s78, s78, 160
    s_mul_i32 s79, s87, 40
    s_add_u32 s78, s78, s79
    v_add_u32 v16, s78, v1
    v_mul_u32_u24 v16, 1280, v16
    v_lshrrev_b32 v17, 1, v1
    s_add_u32 s79, s87, 0
    s_and_b32 s79, s79, 1
    s_lshl_b32 s79, s79, 2
    v_or_b32 v18, s79, v17
    v_xor_b32 v18, v18, v2
    v_lshl_add_u32 v18, v18, 4, v16
    v_add_u32 v8, 0, v18
    s_add_u32 s79, s87, 1
    s_and_b32 s79, s79, 1
    s_lshl_b32 s79, s79, 2
    v_or_b32 v18, s79, v17
    v_xor_b32 v18, v18, v2
    v_lshl_add_u32 v18, v18, 4, v16
    v_add_u32 v9, 9216, v18
    s_add_u32 s79, s87, 2
    s_and_b32 s79, s79, 1
    s_lshl_b32 s79, s79, 2
    v_or_b32 v18, s79, v17
    v_xor_b32 v18, v18, v2
    v_lshl_add_u32 v18, v18, 4, v16
    v_add_u32 v10, 18432, v18
    s_add_u32 s79, s87, 3
    s_and_b32 s79, s79, 1
    s_lshl_b32 s79, s79, 2
    v_or_b32 v18, s79, v17
    v_xor_b32 v18, v18, v2
    v_lshl_add_u32 v18, v18, 4, v16
    v_add_u32 v11, 27648, v18
    s_add_u32 s79, s87, 4
    s_and_b32 s79, s79, 1
    s_lshl_b32 s79, s79, 2
    v_or_b32 v18, s79, v17
    v_xor_b32 v18, v18, v2
    v_lshl_add_u32 v18, v18, 4, v16
    v_add_u32 v12, 40960, v18
    s_mul_i32 s89, s87, 5120
    s_and_b32 s15, s73, 7
    s_mul_i32 s15, s15, 5
    s_lshr_b32 s15, s15, 2
    s_and_b32 s78, s74, 1
    s_mul_i32 s78, s78, 5
    s_add_u32 s15, s15, s78
    s_and_b32 s78, s74, 2
    s_add_u32 s15, s15, s78
    s_sub_u32 s78, s15, 10
    s_cmp_ge_u32 s15, 10
    s_cselect_b32 s15, s78, s15
    s_mul_i32 s91, s15, 128
    s_add_u32 m0, s89, 65536
    s_nop 0
    buffer_load_dwordx4 v8, s[44:47], s91 offen lds
    buffer_load_dwordx4 v9, s[44:47], s91 offen offset:1024 lds
    buffer_load_dwordx4 v10, s[44:47], s91 offen offset:2048 lds
    buffer_load_dwordx4 v11, s[44:47], s91 offen offset:3072 lds
    s_add_u32 m0, s89, 69632
    s_nop 0
    buffer_load_dwordx4 v12, s[44:47], s91 offen lds
    s_add_u32 s91, s91, 128
    s_cmp_eq_u32 s91, 1280
    s_cselect_b32 s91, 0, s91
    s_add_u32 m0, s88, 16384
    s_nop 0
    buffer_load_dwordx4 v4, s[32:35], s90 offen lds
    buffer_load_dwordx4 v5, s[32:35], s90 offen offset:1024 lds
    buffer_load_dwordx4 v6, s[32:35], s90 offen offset:2048 lds
    buffer_load_dwordx4 v7, s[32:35], s90 offen offset:3072 lds
    s_add_u32 s90, s90, 128
    s_cmp_eq_u32 s90, 1280
    s_cselect_b32 s90, 0, s90
    s_add_u32 m0, s89, 86016
    s_nop 0
    buffer_load_dwordx4 v8, s[44:47], s91 offen lds
    buffer_load_dwordx4 v9, s[44:47], s91 offen offset:1024 lds
    buffer_load_dwordx4 v10, s[44:47], s91 offen offset:2048 lds
    buffer_load_dwordx4 v11, s[44:47], s91 offen offset:3072 lds
    s_add_u32 m0, s89, 90112
    s_nop 0
    buffer_load_dwordx4 v12, s[44:47], s91 offen lds
    s_add_u32 s91, s91, 128
    s_cmp_eq_u32 s91, 1280
    s_cselect_b32 s91, 0, s91
    s_add_u32 m0, s88, 32768
    s_nop 0
    buffer_load_dwordx4 v4, s[32:35], s90 offen lds
    buffer_load_dwordx4 v5, s[32:35], s90 offen offset:1024 lds
    buffer_load_dwordx4 v6, s[32:35], s90 offen offset:2048 lds
    buffer_load_dwordx4 v7, s[32:35], s90 offen offset:3072 lds
    s_add_u32 s90, s90, 128
    s_cmp_eq_u32 s90, 1280
    s_cselect_b32 s90, 0, s90
    s_add_u32 m0, s89, 106496
    s_nop 0
    buffer_load_dwordx4 v8, s[44:47], s91 offen lds
    buffer_load_dwordx4 v9, s[44:47], s91 offen offset:1024 lds
    buffer_load_dwordx4 v10, s[44:47], s91 offen offset:2048 lds
    buffer_load_dwordx4 v11, s[44:47], s91 offen offset:3072 lds
    s_add_u32 m0, s89, 110592
    s_nop 0
    buffer_load_dwordx4 v12, s[44:47], s91 offen lds
    s_add_u32 s91, s91, 128
    s_cmp_eq_u32 s91, 1280
    s_cselect_b32 s91, 0, s91
    s_waitcnt vmcnt(18)
    s_barrier
    s_add_u32 m0, s88, 49152
    s_nop 0
    buffer_load_dwordx4 v4, s[32:35], s90 offen lds
    buffer_load_dwordx4 v5, s[32:35], s90 offen offset:1024 lds
    buffer_load_dwordx4 v6, s[32:35], s90 offen offset:2048 lds
    buffer_load_dwordx4 v7, s[32:35], s90 offen offset:3072 lds
    s_add_u32 s90, s90, 128
    s_cmp_eq_u32 s90, 1280
    s_cselect_b32 s90, 0, s90
    s_add_u32 m0, s89, 126976
    s_nop 0
    buffer_load_dwordx4 v8, s[44:47], s91 offen lds
    buffer_load_dwordx4 v9, s[44:47], s91 offen offset:1024 lds
    buffer_load_dwordx4 v10, s[44:47], s91 offen offset:2048 lds
    buffer_load_dwordx4 v11, s[44:47], s91 offen offset:3072 lds
    s_add_u32 m0, s89, 131072
    s_nop 0
    buffer_load_dwordx4 v12, s[44:47], s91 offen lds
    s_add_u32 s91, s91, 128
    s_cmp_eq_u32 s91, 1280
    s_cselect_b32 s91, 0, s91
    s_waitcnt vmcnt(18)
    s_barrier
    s_add_u32 m0, s88, 0
    s_nop 0
    buffer_load_dwordx4 v4, s[32:35], s90 offen lds
    buffer_load_dwordx4 v5, s[32:35], s90 offen offset:1024 lds
    buffer_load_dwordx4 v6, s[32:35], s90 offen offset:2048 lds
    buffer_load_dwordx4 v7, s[32:35], s90 offen offset:3072 lds
    s_add_u32 s90, s90, 128
    s_cmp_eq_u32 s90, 1280
    s_cselect_b32 s90, 0, s90
    s_add_u32 m0, s89, 65536
    s_nop 0
    buffer_load_dwordx4 v8, s[44:47], s91 offen lds
    buffer_load_dwordx4 v9, s[44:47], s91 offen offset:1024 lds
    buffer_load_dwordx4 v10, s[44:47], s91 offen offset:2048 lds
    buffer_load_dwordx4 v11, s[44:47], s91 offen offset:3072 lds
    s_add_u32 m0, s89, 69632
    s_nop 0
    buffer_load_dwordx4 v12, s[44:47], s91 offen lds
    s_add_u32 s91, s91, 128
    s_cmp_eq_u32 s91, 1280
    s_cselect_b32 s91, 0, s91
    s_waitcnt vmcnt(18)
    s_barrier
    s_add_u32 m0, s88, 16384
    s_nop 0
    buffer_load_dwordx4 v4, s[32:35], s90 offen lds
    buffer_load_dwordx4 v5, s[32:35], s90 offen offset:1024 lds
    buffer_load_dwordx4 v6, s[32:35], s90 offen offset:2048 lds
    buffer_load_dwordx4 v7, s[32:35], s90 offen offset:3072 lds
    s_add_u32 s90, s90, 128
    s_cmp_eq_u32 s90, 1280
    s_cselect_b32 s90, 0, s90
    s_add_u32 m0, s89, 86016
    s_nop 0
    buffer_load_dwordx4 v8, s[44:47], s91 offen lds
    buffer_load_dwordx4 v9, s[44:47], s91 offen offset:1024 lds
    buffer_load_dwordx4 v10, s[44:47], s91 offen offset:2048 lds
    buffer_load_dwordx4 v11, s[44:47], s91 offen offset:3072 lds
    s_add_u32 m0, s89, 90112
    s_nop 0
    buffer_load_dwordx4 v12, s[44:47], s91 offen lds
    s_add_u32 s91, s91, 128
    s_cmp_eq_u32 s91, 1280
    s_cselect_b32 s91, 0, s91
    v_lshlrev_b32 v64, 2, v2
    buffer_load_dword v72, v64, s[68:71], 0 offen
    s_waitcnt vmcnt(19)
    s_barrier
    s_add_u32 m0, s88, 32768
    s_nop 0
    buffer_load_dwordx4 v4, s[32:35], s90 offen lds
    buffer_load_dwordx4 v5, s[32:35], s90 offen offset:1024 lds
    buffer_load_dwordx4 v6, s[32:35], s90 offen offset:2048 lds
    buffer_load_dwordx4 v7, s[32:35], s90 offen offset:3072 lds
    s_add_u32 s90, s90, 128
    s_cmp_eq_u32 s90, 1280
    s_cselect_b32 s90, 0, s90
    s_add_u32 m0, s89, 106496
    s_nop 0
    buffer_load_dwordx4 v8, s[44:47], s91 offen lds
    buffer_load_dwordx4 v9, s[44:47], s91 offen offset:1024 lds
    buffer_load_dwordx4 v10, s[44:47], s91 offen offset:2048 lds
    buffer_load_dwordx4 v11, s[44:47], s91 offen offset:3072 lds
    s_add_u32 m0, s89, 110592
    s_nop 0
    buffer_load_dwordx4 v12, s[44:47], s91 offen lds
    s_add_u32 s91, s91, 128
    s_cmp_eq_u32 s91, 1280
    s_cselect_b32 s91, 0, s91
    s_waitcnt vmcnt(19)
    s_waitcnt vmcnt(9)
    v_cmp_ne_u32 vcc, 1, v72
    s_cbranch_vccz Lok_35
    s_mov_b32 s92, 0x20000
Lpoll_36:
    buffer_load_dword v72, v64, s[68:71], 0 offen sc1
    s_waitcnt vmcnt(0)
    v_cmp_ne_u32 vcc, 1, v72
    s_cbranch_vccz Lpd_37
    s_sleep 16
    s_sub_u32 s92, s92, 1
    s_cmp_lg_u32 s92, 0
    s_cbranch_scc1 Lpoll_36
Lpd_37:
Lok_35:
    s_barrier
    s_mul_i32 s78, s72, 6
    s_lshr_b32 s80, s87, 1
    s_add_u32 s78, s78, s74
    s_add_u32 s78, s78, 2
    s_lshl_b32 s78, s78, 7
    s_mul_i32 s80, s80, 98304
    s_add_u32 s78, s78, s80
    v_mul_u32_u24 v16, 3072, v1
    v_add_u32 v16, s78, v16
    v_and_b32 v17, 2, v1
    v_or_b32 v18, 0, v17
    v_xor_b32 v18, v18, v2
    v_lshl_add_u32 v18, v18, 4, v16
    v_add_u32 v84, 0, v18
    v_or_b32 v18, 4, v17
    v_xor_b32 v18, v18, v2
    v_lshl_add_u32 v18, v18, 4, v16
    v_add_u32 v85, 23552, v18
    v_or_b32 v18, 0, v17
    v_xor_b32 v18, v18, v2
    v_lshl_add_u32 v18, v18, 4, v16
    v_add_u32 v86, 47104, v18
    v_or_b32 v18, 4, v17
    v_xor_b32 v18, v18, v2
    v_lshl_add_u32 v18, v18, 4, v16
    v_add_u32 v87, 70656, v18
    s_and_b32 s20, s87, 1
    s_lshl_b32 s20, s20, 13
    s_lshr_b32 s78, s87, 1
    s_lshl_b32 s78, s78, 12
    s_add_u32 s20, s20, s78
    s_and_b32 s15, s73, 7
    s_mul_i32 s15, s15, 5
    s_lshr_b32 s15, s15, 2
    s_and_b32 s78, s74, 1
    s_mul_i32 s78, s78, 5
    s_add_u32 s15, s15, s78
    s_and_b32 s78, s74, 2
    s_add_u32 s15, s15, s78
    s_sub_u32 s78, s15, 10
    s_cmp_ge_u32 s15, 10
    s_cselect_b32 s15, s78, s15
    s_add_u32 s15, s15, 6
    s_sub_u32 s78, s15, 10
    s_cmp_ge_u32 s15, 10
    s_cselect_b32 s15, s78, s15
    s_mul_i32 s21, s15, 196608
    s_add_u32 m0, s20, 126976
    s_nop 0
    buffer_load_dwordx4 v84, s[48:51], s21 offen lds
    buffer_load_dwordx4 v85, s[48:51], s21 offen offset:1024 lds
    buffer_load_dwordx4 v86, s[48:51], s21 offen offset:2048 lds
    buffer_load_dwordx4 v87, s[48:51], s21 offen offset:3072 lds
    s_add_u32 s21, s21, 196608
    s_cmp_eq_u32 s21, 1966080
    s_cselect_b32 s21, 0, s21
    s_add_u32 m0, s88, 49152
    s_nop 0
    buffer_load_dwordx4 v4, s[32:35], s90 offen lds
    buffer_load_dwordx4 v5, s[32:35], s90 offen offset:1024 lds
    buffer_load_dwordx4 v6, s[32:35], s90 offen offset:2048 lds
    buffer_load_dwordx4 v7, s[32:35], s90 offen offset:3072 lds
    s_add_u32 s90, s90, 128
    s_cmp_eq_u32 s90, 1280
    s_cselect_b32 s90, 0, s90
    s_barrier
    s_add_u32 m0, s89, 65536
    s_nop 0
    buffer_load_dwordx4 v8, s[44:47], s91 offen lds
    buffer_load_dwordx4 v9, s[44:47], s91 offen offset:1024 lds
    buffer_load_dwordx4 v10, s[44:47], s91 offen offset:2048 lds
    buffer_load_dwordx4 v11, s[44:47], s91 offen offset:3072 lds
    s_add_u32 m0, s89, 69632
    s_nop 0
    buffer_load_dwordx4 v12, s[44:47], s91 offen lds
    s_add_u32 s91, s91, 128
    s_cmp_eq_u32 s91, 1280
    s_cselect_b32 s91, 0, s91
    s_add_u32 m0, s88, 0
    s_nop 0
    buffer_load_dwordx4 v4, s[32:35], s90 offen lds
    buffer_load_dwordx4 v5, s[32:35], s90 offen offset:1024 lds
    buffer_load_dwordx4 v6, s[32:35], s90 offen offset:2048 lds
    buffer_load_dwordx4 v7, s[32:35], s90 offen offset:3072 lds
    s_add_u32 s90, s90, 128
    s_cmp_eq_u32 s90, 1280
    s_cselect_b32 s90, 0, s90
    s_waitcnt vmcnt(17)
    s_barrier
    s_add_u32 m0, s20, 86016
    s_nop 0
    buffer_load_dwordx4 v84, s[48:51], s21 offen lds
    buffer_load_dwordx4 v85, s[48:51], s21 offen offset:1024 lds
    buffer_load_dwordx4 v86, s[48:51], s21 offen offset:2048 lds
    buffer_load_dwordx4 v87, s[48:51], s21 offen offset:3072 lds
    s_add_u32 s21, s21, 196608
    s_cmp_eq_u32 s21, 1966080
    s_cselect_b32 s21, 0, s21
    s_add_u32 m0, s88, 16384
    s_nop 0
    buffer_load_dwordx4 v4, s[32:35], s90 offen lds
    buffer_load_dwordx4 v5, s[32:35], s90 offen offset:1024 lds
    buffer_load_dwordx4 v6, s[32:35], s90 offen offset:2048 lds
    buffer_load_dwordx4 v7, s[32:35], s90 offen offset:3072 lds
    s_add_u32 s90, s90, 128
    s_cmp_eq_u32 s90, 1280
    s_cselect_b32 s90, 0, s90
    s_waitcnt vmcnt(21)
    s_barrier
    s_add_u32 m0, s89, 106496
    s_nop 0
    buffer_load_dwordx4 v8, s[44:47], s91 offen lds
    buffer_load_dwordx4 v9, s[44:47], s91 offen offset:1024 lds
    buffer_load_dwordx4 v10, s[44:47], s91 offen offset:2048 lds
    buffer_load_dwordx4 v11, s[44:47], s91 offen offset:3072 lds
    s_add_u32 m0, s89, 110592
    s_nop 0
    buffer_load_dwordx4 v12, s[44:47], s91 offen lds
    s_add_u32 s91, s91, 128
    s_cmp_eq_u32 s91, 1280
    s_cselect_b32 s91, 0, s91
    s_waitcnt vmcnt(17)
    s_barrier
    s_add_u32 m0, s20, 126976
    s_nop 0
    buffer_load_dwordx4 v84, s[48:51], s21 offen lds
    buffer_load_dwordx4 v85, s[48:51], s21 offen offset:1024 lds
    buffer_load_dwordx4 v86, s[48:51], s21 offen offset:2048 lds
    buffer_load_dwordx4 v87, s[48:51], s21 offen offset:3072 lds
    s_add_u32 s21, s21, 196608
    s_cmp_eq_u32 s21, 1966080
    s_cselect_b32 s21, 0, s21
    s_add_u32 m0, s88, 32768
    s_nop 0
    buffer_load_dwordx4 v4, s[32:35], s90 offen lds
    buffer_load_dwordx4 v5, s[32:35], s90 offen offset:1024 lds
    buffer_load_dwordx4 v6, s[32:35], s90 offen offset:2048 lds
    buffer_load_dwordx4 v7, s[32:35], s90 offen offset:3072 lds
    s_add_u32 s90, s90, 128
    s_cmp_eq_u32 s90, 1280
    s_cselect_b32 s90, 0, s90
    s_waitcnt vmcnt(17)
    s_barrier
    s_add_u32 m0, s89, 65536
    s_nop 0
    buffer_load_dwordx4 v8, s[44:47], s91 offen lds
    buffer_load_dwordx4 v9, s[44:47], s91 offen offset:1024 lds
    buffer_load_dwordx4 v10, s[44:47], s91 offen offset:2048 lds
    buffer_load_dwordx4 v11, s[44:47], s91 offen offset:3072 lds
    s_add_u32 m0, s89, 69632
    s_nop 0
    buffer_load_dwordx4 v12, s[44:47], s91 offen lds
    s_add_u32 s91, s91, 128
    s_cmp_eq_u32 s91, 1280
    s_cselect_b32 s91, 0, s91
    s_waitcnt vmcnt(13)
    s_barrier
    s_add_u32 m0, s20, 86016
    s_nop 0
    buffer_load_dwordx4 v84, s[48:51], s21 offen lds
    buffer_load_dwordx4 v85, s[48:51], s21 offen offset:1024 lds
    buffer_load_dwordx4 v86, s[48:51], s21 offen offset:2048 lds
    buffer_load_dwordx4 v87, s[48:51], s21 offen offset:3072 lds
    s_add_u32 s21, s21, 196608
    s_cmp_eq_u32 s21, 1966080
    s_cselect_b32 s21, 0, s21
    s_add_u32 m0, s88, 49152
    s_nop 0
    buffer_load_dwordx4 v4, s[32:35], s90 offen lds
    buffer_load_dwordx4 v5, s[32:35], s90 offen offset:1024 lds
    buffer_load_dwordx4 v6, s[32:35], s90 offen offset:2048 lds
    buffer_load_dwordx4 v7, s[32:35], s90 offen offset:3072 lds
    s_add_u32 s90, s90, 128
    s_cmp_eq_u32 s90, 1280
    s_cselect_b32 s90, 0, s90
    s_waitcnt vmcnt(17)
    s_barrier
    s_add_u32 m0, s20, 106496
    s_nop 0
    buffer_load_dwordx4 v84, s[48:51], s21 offen lds
    buffer_load_dwordx4 v85, s[48:51], s21 offen offset:1024 lds
    buffer_load_dwordx4 v86, s[48:51], s21 offen offset:2048 lds
    buffer_load_dwordx4 v87, s[48:51], s21 offen offset:3072 lds
    s_add_u32 s21, s21, 196608
    s_cmp_eq_u32 s21, 1966080
    s_cselect_b32 s21, 0, s21
    s_waitcnt vmcnt(12)
    s_barrier
    s_add_u32 m0, s20, 126976
    s_nop 0
    buffer_load_dwordx4 v84, s[48:51], s21 offen lds
    buffer_load_dwordx4 v85, s[48:51], s21 offen offset:1024 lds
    buffer_load_dwordx4 v86, s[48:51], s21 offen offset:2048 lds
    buffer_load_dwordx4 v87, s[48:51], s21 offen offset:3072 lds
    s_add_u32 s21, s21, 196608
    s_cmp_eq_u32 s21, 1966080
    s_cselect_b32 s21, 0, s21
    s_add_u32 m0, s88, 0
    s_nop 0
    buffer_load_dwordx4 v4, s[32:35], s90 offen lds
    buffer_load_dwordx4 v5, s[32:35], s90 offen offset:1024 lds
    buffer_load_dwordx4 v6, s[32:35], s90 offen offset:2048 lds
    buffer_load_dwordx4 v7, s[32:35], s90 offen offset:3072 lds
    s_add_u32 s90, s90, 128
    s_cmp_eq_u32 s90, 1280
    s_cselect_b32 s90, 0, s90
    s_waitcnt vmcnt(16)
    s_barrier
    s_add_u32 m0, s20, 65536
    s_nop 0
    buffer_load_dwordx4 v84, s[48:51], s21 offen lds
    buffer_load_dwordx4 v85, s[48:51], s21 offen offset:1024 lds
    buffer_load_dwordx4 v86, s[48:51], s21 offen offset:2048 lds
    buffer_load_dwordx4 v87, s[48:51], s21 offen offset:3072 lds
    s_add_u32 s21, s21, 196608
    s_cmp_eq_u32 s21, 1966080
    s_cselect_b32 s21, 0, s21
    s_barrier
    s_add_u32 m0, s88, 16384
    s_nop 0
    buffer_load_dwordx4 v4, s[32:35], s90 offen lds
    buffer_load_dwordx4 v5, s[32:35], s90 offen offset:1024 lds
    buffer_load_dwordx4 v6, s[32:35], s90 offen offset:2048 lds
    buffer_load_dwordx4 v7, s[32:35], s90 offen offset:3072 lds
    s_add_u32 s90, s90, 128
    s_cmp_eq_u32 s90, 1280
    s_cselect_b32 s90, 0, s90
    s_add_u32 m0, s20, 86016
    s_nop 0
    buffer_load_dwordx4 v84, s[48:51], s21 offen lds
    buffer_load_dwordx4 v85, s[48:51], s21 offen offset:1024 lds
    buffer_load_dwordx4 v86, s[48:51], s21 offen offset:2048 lds
    buffer_load_dwordx4 v87, s[48:51], s21 offen offset:3072 lds
    s_add_u32 s21, s21, 196608
    s_cmp_eq_u32 s21, 1966080
    s_cselect_b32 s21, 0, s21
    s_waitcnt vmcnt(20)
    s_barrier
    s_andn2_b32 s78, s2, 0x1b
    v_and_b32 v16, 3, v0
    v_lshlrev_b32 v16, 3, v16
    v_bfe_u32 v17, v0, 2, 2
    v_add3_u32 v64, v16, v17, s78
    v_lshlrev_b32 v64, 7, v64
    v_add_u32 v64, 32505916, v64
    buffer_load_dword v72, v64, s[60:63], 0 offen sc1
    s_waitcnt vmcnt(17)
    s_barrier
    s_add_u32 m0, s88, 32768
    s_nop 0
    buffer_load_dwordx4 v4, s[32:35], s90 offen lds
    buffer_load_dwordx4 v5, s[32:35], s90 offen offset:1024 lds
    buffer_load_dwordx4 v6, s[32:35], s90 offen offset:2048 lds
    buffer_load_dwordx4 v7, s[32:35], s90 offen offset:3072 lds
    s_add_u32 s90, s90, 128
    s_cmp_eq_u32 s90, 1280
    s_cselect_b32 s90, 0, s90
    s_add_u32 m0, s20, 106496
    s_nop 0
    buffer_load_dwordx4 v84, s[48:51], s21 offen lds
    buffer_load_dwordx4 v85, s[48:51], s21 offen offset:1024 lds
    buffer_load_dwordx4 v86, s[48:51], s21 offen offset:2048 lds
    buffer_load_dwordx4 v87, s[48:51], s21 offen offset:3072 lds
    s_add_u32 s21, s21, 196608
    s_cmp_eq_u32 s21, 1966080
    s_cselect_b32 s21, 0, s21
    s_waitcnt vmcnt(17)
    s_barrier
    s_waitcnt vmcnt(8)
    v_cmp_ne_u32 vcc, 1, v72
    s_cbranch_vccz Lok_38
    s_mov_b32 s92, 0x20000
Lpoll_39:
    buffer_load_dword v72, v64, s[60:63], 0 offen sc1
    s_waitcnt vmcnt(0)
    v_cmp_ne_u32 vcc, 1, v72
    s_cbranch_vccz Lpd_40
    s_sleep 8
    s_sub_u32 s92, s92, 1
    s_cmp_lg_u32 s92, 0
    s_cbranch_scc1 Lpoll_39
Lpd_40:
Lok_38:
    v_and_b32 v16, 31, v0
    v_lshlrev_b32 v60, 2, v16
    s_lshl_b32 s78, s73, 9
    s_lshl_b32 s79, s87, 7
    s_add_u32 s78, s78, s79
    s_add_u32 s78, s78, 32538624
    buffer_load_dword v32, v60, s[60:63], s78 offen sc1
    s_add_u32 m0, s88, 49152
    s_nop 0
    buffer_load_dwordx4 v4, s[32:35], s90 offen lds
    buffer_load_dwordx4 v5, s[32:35], s90 offen offset:1024 lds
    buffer_load_dwordx4 v6, s[32:35], s90 offen offset:2048 lds
    buffer_load_dwordx4 v7, s[32:35], s90 offen offset:3072 lds
    s_add_u32 s90, s90, 128
    s_cmp_eq_u32 s90, 1280
    s_cselect_b32 s90, 0, s90
    s_add_u32 m0, s20, 126976
    s_nop 0
    buffer_load_dwordx4 v84, s[48:51], s21 offen lds
    buffer_load_dwordx4 v85, s[48:51], s21 offen offset:1024 lds
    buffer_load_dwordx4 v86, s[48:51], s21 offen offset:2048 lds
    buffer_load_dwordx4 v87, s[48:51], s21 offen offset:3072 lds
    s_add_u32 s21, s21, 196608
    s_cmp_eq_u32 s21, 1966080
    s_cselect_b32 s21, 0, s21
    s_barrier
    v_lshrrev_b32 v17, 1, v1
    s_lshl_b32 s78, s87, 5
    s_lshl_b32 s79, s72, 4
    s_lshl_b32 s80, s73, 7
    s_lshl_b32 s81, s72, 10
    s_add_u32 s81, s81, 4096
    s_add_u32 s82, s78, 0
    s_xor_b32 s82, s82, s79
    s_add_u32 s82, s82, s80
    v_add_u32 v16, s82, v1
    v_lshlrev_b32 v16, 12, v16
    v_or_b32 v18, 0, v17
    v_xor_b32 v18, v18, v2
    v_lshl_add_u32 v18, v18, 4, v16
    s_sub_u32 s82, s81, 0
    v_add_u32 v4, s82, v18
    s_add_u32 s82, s78, 8
    s_xor_b32 s82, s82, s79
    s_add_u32 s82, s82, s80
    v_add_u32 v16, s82, v1
    v_lshlrev_b32 v16, 12, v16
    v_or_b32 v18, 4, v17
    v_xor_b32 v18, v18, v2
    v_lshl_add_u32 v18, v18, 4, v16
    s_sub_u32 s82, s81, 1024
    v_add_u32 v5, s82, v18
    s_add_u32 s82, s78, 16
    s_xor_b32 s82, s82, s79
    s_add_u32 s82, s82, s80
    v_add_u32 v16, s82, v1
    v_lshlrev_b32 v16, 12, v16
    v_or_b32 v18, 0, v17
    v_xor_b32 v18, v18, v2
    v_lshl_add_u32 v18, v18, 4, v16
    s_sub_u32 s82, s81, 2048
    v_add_u32 v6, s82, v18
    s_add_u32 s82, s78, 24
    s_xor_b32 s82, s82, s79
    s_add_u32 s82, s82, s80
    v_add_u32 v16, s82, v1
    v_lshlrev_b32 v16, 12, v16
    v_or_b32 v18, 4, v17
    v_xor_b32 v18, v18, v2
    v_lshl_add_u32 v18, v18, 4, v16
    s_sub_u32 s82, s81, 3072
    v_add_u32 v7, s82, v18
    s_lshl_b32 s15, s74, 1
    s_add_u32 s15, s15, s73
    s_lshl_b32 s15, s15, 1
    s_and_b32 s15, s15, 15
    s_mov_b32 s12, s15
    s_mov_b32 s10, 8392704
    s_mov_b32 s11, 0x20000
    s_cmp_lt_u32 s12, 8
    s_cselect_b32 s8, s36, s40
    s_cselect_b32 s9, s37, s41
    s_and_b32 s90, s12, 7
    s_lshl_b32 s90, s90, 7
    s_add_u32 m0, s88, 0
    s_nop 0
    buffer_load_dwordx4 v4, s[8:11], s90 offen lds
    buffer_load_dwordx4 v5, s[8:11], s90 offen offset:1024 lds
    buffer_load_dwordx4 v6, s[8:11], s90 offen offset:2048 lds
    buffer_load_dwordx4 v7, s[8:11], s90 offen offset:3072 lds
    s_add_u32 s12, s12, 1
    s_and_b32 s12, s12, 15
    s_waitcnt vmcnt(13)
    s_barrier
    s_cmp_lt_u32 s12, 8
    s_cselect_b32 s8, s36, s40
    s_cselect_b32 s9, s37, s41
    s_and_b32 s90, s12, 7
    s_lshl_b32 s90, s90, 7
    s_add_u32 m0, s88, 16384
    s_nop 0
    buffer_load_dwordx4 v4, s[8:11], s90 offen lds
    buffer_load_dwordx4 v5, s[8:11], s90 offen offset:1024 lds
    buffer_load_dwordx4 v6, s[8:11], s90 offen offset:2048 lds
    buffer_load_dwordx4 v7, s[8:11], s90 offen offset:3072 lds
    s_add_u32 s12, s12, 1
    s_and_b32 s12, s12, 15
    v_and_b32 v16, 3, v0
    s_lshl_b32 s78, s72, 2
    v_add_u32 v16, s78, v16
    v_and_b32 v17, 4, v0
    v_add_u32 v17, s74, v17
    v_and_b32 v18, 7, v16
    v_lshlrev_b32 v18, 5, v18
    v_and_b32 v19, 1, v17
    v_add_u32 v19, 2, v19
    v_lshl_add_u32 v18, v19, 3, v18
    v_lshrrev_b32 v19, 3, v16
    v_lshl_add_u32 v18, v19, 2, v18
    v_lshrrev_b32 v19, 1, v17
    v_add_u32 v65, v18, v19
    v_lshlrev_b32 v65, 7, v65
    v_add_u32 v65, 32505856, v65
    buffer_load_dwordx4 v[76:79], v65, s[60:63], 0 offen sc1
    s_waitcnt vmcnt(9)
    s_barrier
    s_cmp_lt_u32 s12, 8
    s_cselect_b32 s8, s36, s40
    s_cselect_b32 s9, s37, s41
    s_and_b32 s90, s12, 7
    s_lshl_b32 s90, s90, 7
    s_add_u32 m0, s88, 32768
    s_nop 0
    buffer_load_dwordx4 v4, s[8:11], s90 offen lds
    buffer_load_dwordx4 v5, s[8:11], s90 offen offset:1024 lds
    buffer_load_dwordx4 v6, s[8:11], s90 offen offset:2048 lds
    buffer_load_dwordx4 v7, s[8:11], s90 offen offset:3072 lds
    s_add_u32 s12, s12, 1
    s_and_b32 s12, s12, 15
    s_mov_b32 s78, 0x3fb8aa3b
    s_mov_b32 s79, 0x42ad1f97
    s_lshl_b32 s80, s87, 7
    s_add_u32 s80, s80, 147456
    v_add_u32 v24, s80, v60
    v_mul_f32 v32, s78, v32
    v_min_f32 v16, s79, v32
    v_exp_f32 v16, v16
    v_exp_f32 v17, -v32
    s_nop 0
    v_add_f32 v16, 1.0, v16
    v_add_f32 v17, 1.0, v17
    v_rcp_f32 v17, v17
    s_nop 0
    ds_write_b32 v24, v16 offset:2048
    ds_write_b32 v24, v17 offset:2560
    s_waitcnt lgkmcnt(0)
    s_barrier
    s_lshl_b32 s78, s74, 6
    s_lshl_b32 s79, s72, 4
    s_add_u32 s78, s78, s79
    s_mul_i32 s78, s78, 10240
    s_mul_i32 s79, s87, 5120
    s_add_u32 s78, s78, s79
    s_add_u32 s78, s78, 0
    v_lshlrev_b32 v16, 4, v0
    v_add_u32 v8, s78, v16
    v_add_u32 v9, s78, v16
    v_add_u32 v10, s78, v16
    v_add_u32 v11, s78, v16
    v_add_u32 v12, 4096, v8
    s_mul_i32 s89, s87, 5120
    s_lshl_b32 s15, s74, 1
    s_add_u32 s15, s15, s73
    s_lshl_b32 s15, s15, 1
    s_and_b32 s15, s15, 15
    s_mov_b32 s13, s15
    s_waitcnt vmcnt(4)
    v_and_b32 v76, v76, v77
    v_and_b32 v78, v78, v79
    v_and_b32 v76, v76, v78
    v_cmp_ne_u32 vcc, 1, v76
    s_cbranch_vccz Lok_41
    s_mov_b32 s92, 0x20000
Lpoll_42:
    buffer_load_dwordx4 v[76:79], v65, s[60:63], 0 offen sc1
    s_waitcnt vmcnt(0)
    v_and_b32 v76, v76, v77
    v_and_b32 v78, v78, v79
    v_and_b32 v76, v76, v78
    v_cmp_ne_u32 vcc, 1, v76
    s_cbranch_vccz Lpd_43
    s_sleep 2
    s_sub_u32 s92, s92, 1
    s_cmp_lg_u32 s92, 0
    s_cbranch_scc1 Lpoll_42
Lpd_43:
Lok_41:
    s_lshr_b32 s78, s13, 3
    s_mul_i32 s78, s78, 2621440
    s_and_b32 s91, s13, 7
    s_mul_i32 s91, s91, 20480
    s_add_u32 s91, s91, s78
    s_add_u32 m0, s89, 65536
    s_nop 0
    buffer_load_dwordx4 v8, s[60:63], s91 offen sc1 lds
    buffer_load_dwordx4 v9, s[60:63], s91 offen offset:1024 sc1 lds
    buffer_load_dwordx4 v10, s[60:63], s91 offen offset:2048 sc1 lds
    buffer_load_dwordx4 v11, s[60:63], s91 offen offset:3072 sc1 lds
    s_add_u32 m0, s89, 69632
    s_nop 0
    buffer_load_dwordx4 v12, s[60:63], s91 offen sc1 lds
    s_add_u32 s13, s13, 1
    s_and_b32 s13, s13, 15
    s_cmp_lt_u32 s12, 8
    s_cselect_b32 s8, s36, s40
    s_cselect_b32 s9, s37, s41
    s_and_b32 s90, s12, 7
    s_lshl_b32 s90, s90, 7
    s_add_u32 m0, s88, 49152
    s_nop 0
    buffer_load_dwordx4 v4, s[8:11], s90 offen lds
    buffer_load_dwordx4 v5, s[8:11], s90 offen offset:1024 lds
    buffer_load_dwordx4 v6, s[8:11], s90 offen offset:2048 lds
    buffer_load_dwordx4 v7, s[8:11], s90 offen offset:3072 lds
    s_add_u32 s12, s12, 1
    s_and_b32 s12, s12, 15
    s_waitcnt vmcnt(4)
    s_barrier
    s_lshr_b32 s78, s13, 3
    s_mul_i32 s78, s78, 2621440
    s_and_b32 s91, s13, 7
    s_mul_i32 s91, s91, 20480
    s_add_u32 s91, s91, s78
    s_add_u32 m0, s89, 86016
    s_nop 0
    buffer_load_dwordx4 v8, s[60:63], s91 offen sc1 lds
    buffer_load_dwordx4 v9, s[60:63], s91 offen offset:1024 sc1 lds
    buffer_load_dwordx4 v10, s[60:63], s91 offen offset:2048 sc1 lds
    buffer_load_dwordx4 v11, s[60:63], s91 offen offset:3072 sc1 lds
    s_add_u32 m0, s89, 90112
    s_nop 0
    buffer_load_dwordx4 v12, s[60:63], s91 offen sc1 lds
    s_add_u32 s13, s13, 1
    s_and_b32 s13, s13, 15
    s_lshr_b32 s78, s13, 3
    s_mul_i32 s78, s78, 2621440
    s_and_b32 s91, s13, 7
    s_mul_i32 s91, s91, 20480
    s_add_u32 s91, s91, s78
    s_add_u32 m0, s89, 106496
    s_nop 0
    buffer_load_dwordx4 v8, s[60:63], s91 offen sc1 lds
    buffer_load_dwordx4 v9, s[60:63], s91 offen offset:1024 sc1 lds
    buffer_load_dwordx4 v10, s[60:63], s91 offen offset:2048 sc1 lds
    buffer_load_dwordx4 v11, s[60:63], s91 offen offset:3072 sc1 lds
    s_add_u32 m0, s89, 110592
    s_nop 0
    buffer_load_dwordx4 v12, s[60:63], s91 offen sc1 lds
    s_add_u32 s13, s13, 1
    s_and_b32 s13, s13, 15
    s_waitcnt vmcnt(5)
    s_barrier
    s_lshr_b32 s78, s13, 3
    s_mul_i32 s78, s78, 2621440
    s_and_b32 s91, s13, 7
    s_mul_i32 s91, s91, 20480
    s_add_u32 s91, s91, s78
    s_add_u32 m0, s89, 126976
    s_nop 0
    buffer_load_dwordx4 v8, s[60:63], s91 offen sc1 lds
    buffer_load_dwordx4 v9, s[60:63], s91 offen offset:1024 sc1 lds
    buffer_load_dwordx4 v10, s[60:63], s91 offen offset:2048 sc1 lds
    buffer_load_dwordx4 v11, s[60:63], s91 offen offset:3072 sc1 lds
    s_add_u32 m0, s89, 131072
    s_nop 0
    buffer_load_dwordx4 v12, s[60:63], s91 offen sc1 lds
    s_add_u32 s13, s13, 1
    s_and_b32 s13, s13, 15
    s_cmp_lt_u32 s12, 8
    s_cselect_b32 s8, s36, s40
    s_cselect_b32 s9, s37, s41
    s_and_b32 s90, s12, 7
    s_lshl_b32 s90, s90, 7
    s_add_u32 m0, s88, 0
    s_nop 0
    buffer_load_dwordx4 v4, s[8:11], s90 offen lds
    buffer_load_dwordx4 v5, s[8:11], s90 offen offset:1024 lds
    buffer_load_dwordx4 v6, s[8:11], s90 offen offset:2048 lds
    buffer_load_dwordx4 v7, s[8:11], s90 offen offset:3072 lds
    s_add_u32 s12, s12, 1
    s_and_b32 s12, s12, 15
    s_lshr_b32 s78, s13, 3
    s_mul_i32 s78, s78, 2621440
    s_and_b32 s91, s13, 7
    s_mul_i32 s91, s91, 20480
    s_add_u32 s91, s91, s78
    s_add_u32 m0, s89, 65536
    s_nop 0
    buffer_load_dwordx4 v8, s[60:63], s91 offen sc1 lds
    buffer_load_dwordx4 v9, s[60:63], s91 offen offset:1024 sc1 lds
    buffer_load_dwordx4 v10, s[60:63], s91 offen offset:2048 sc1 lds
    buffer_load_dwordx4 v11, s[60:63], s91 offen offset:3072 sc1 lds
    s_add_u32 m0, s89, 69632
    s_nop 0
    buffer_load_dwordx4 v12, s[60:63], s91 offen sc1 lds
    s_add_u32 s13, s13, 1
    s_and_b32 s13, s13, 15
    s_waitcnt vmcnt(14)
    s_barrier
    s_cmp_lt_u32 s12, 8
    s_cselect_b32 s8, s36, s40
    s_cselect_b32 s9, s37, s41
    s_and_b32 s90, s12, 7
    s_lshl_b32 s90, s90, 7
    s_add_u32 m0, s88, 16384
    s_nop 0
    buffer_load_dwordx4 v4, s[8:11], s90 offen lds
    buffer_load_dwordx4 v5, s[8:11], s90 offen offset:1024 lds
    buffer_load_dwordx4 v6, s[8:11], s90 offen offset:2048 lds
    buffer_load_dwordx4 v7, s[8:11], s90 offen offset:3072 lds
    s_add_u32 s12, s12, 1
    s_and_b32 s12, s12, 15
    s_lshr_b32 s78, s13, 3
    s_mul_i32 s78, s78, 2621440
    s_and_b32 s91, s13, 7
    s_mul_i32 s91, s91, 20480
    s_add_u32 s91, s91, s78
    s_add_u32 m0, s89, 86016
    s_nop 0
    buffer_load_dwordx4 v8, s[60:63], s91 offen sc1 lds
    buffer_load_dwordx4 v9, s[60:63], s91 offen offset:1024 sc1 lds
    buffer_load_dwordx4 v10, s[60:63], s91 offen offset:2048 sc1 lds
    buffer_load_dwordx4 v11, s[60:63], s91 offen offset:3072 sc1 lds
    s_add_u32 m0, s89, 90112
    s_nop 0
    buffer_load_dwordx4 v12, s[60:63], s91 offen sc1 lds
    s_add_u32 s13, s13, 1
    s_and_b32 s13, s13, 15
    s_waitcnt vmcnt(18)
    s_barrier
    s_cmp_lt_u32 s12, 8
    s_cselect_b32 s8, s36, s40
    s_cselect_b32 s9, s37, s41
    s_and_b32 s90, s12, 7
    s_lshl_b32 s90, s90, 7
    s_add_u32 m0, s88, 32768
    s_nop 0
    buffer_load_dwordx4 v4, s[8:11], s90 offen lds
    buffer_load_dwordx4 v5, s[8:11], s90 offen offset:1024 lds
    buffer_load_dwordx4 v6, s[8:11], s90 offen offset:2048 lds
    buffer_load_dwordx4 v7, s[8:11], s90 offen offset:3072 lds
    s_add_u32 s12, s12, 1
    s_and_b32 s12, s12, 15
    s_lshr_b32 s78, s13, 3
    s_mul_i32 s78, s78, 2621440
    s_and_b32 s91, s13, 7
    s_mul_i32 s91, s91, 20480
    s_add_u32 s91, s91, s78
    s_add_u32 m0, s89, 106496
    s_nop 0
    buffer_load_dwordx4 v8, s[60:63], s91 offen sc1 lds
    buffer_load_dwordx4 v9, s[60:63], s91 offen offset:1024 sc1 lds
    buffer_load_dwordx4 v10, s[60:63], s91 offen offset:2048 sc1 lds
    buffer_load_dwordx4 v11, s[60:63], s91 offen offset:3072 sc1 lds
    s_add_u32 m0, s89, 110592
    s_nop 0
    buffer_load_dwordx4 v12, s[60:63], s91 offen sc1 lds
    s_add_u32 s13, s13, 1
    s_and_b32 s13, s13, 15
    s_waitcnt vmcnt(18)
    s_barrier
    s_cmp_lt_u32 s12, 8
    s_cselect_b32 s8, s36, s40
    s_cselect_b32 s9, s37, s41
    s_and_b32 s90, s12, 7
    s_lshl_b32 s90, s90, 7
    s_add_u32 m0, s88, 49152
    s_nop 0
    buffer_load_dwordx4 v4, s[8:11], s90 offen lds
    buffer_load_dwordx4 v5, s[8:11], s90 offen offset:1024 lds
    buffer_load_dwordx4 v6, s[8:11], s90 offen offset:2048 lds
    buffer_load_dwordx4 v7, s[8:11], s90 offen offset:3072 lds
    s_add_u32 s12, s12, 1
    s_and_b32 s12, s12, 15
    s_lshr_b32 s78, s13, 3
    s_mul_i32 s78, s78, 2621440
    s_and_b32 s91, s13, 7
    s_mul_i32 s91, s91, 20480
    s_add_u32 s91, s91, s78
    s_add_u32 m0, s89, 126976
    s_nop 0
    buffer_load_dwordx4 v8, s[60:63], s91 offen sc1 lds
    buffer_load_dwordx4 v9, s[60:63], s91 offen offset:1024 sc1 lds
    buffer_load_dwordx4 v10, s[60:63], s91 offen offset:2048 sc1 lds
    buffer_load_dwordx4 v11, s[60:63], s91 offen offset:3072 sc1 lds
    s_add_u32 m0, s89, 131072
    s_nop 0
    buffer_load_dwordx4 v12, s[60:63], s91 offen sc1 lds
    s_add_u32 s13, s13, 1
    s_and_b32 s13, s13, 15
    s_waitcnt vmcnt(18)
    s_barrier
    s_cmp_lt_u32 s12, 8
    s_cselect_b32 s8, s36, s40
    s_cselect_b32 s9, s37, s41
    s_and_b32 s90, s12, 7
    s_lshl_b32 s90, s90, 7
    s_add_u32 m0, s88, 0
    s_nop 0
    buffer_load_dwordx4 v4, s[8:11], s90 offen lds
    buffer_load_dwordx4 v5, s[8:11], s90 offen offset:1024 lds
    buffer_load_dwordx4 v6, s[8:11], s90 offen offset:2048 lds
    buffer_load_dwordx4 v7, s[8:11], s90 offen offset:3072 lds
    s_add_u32 s12, s12, 1
    s_and_b32 s12, s12, 15
    s_lshr_b32 s78, s13, 3
    s_mul_i32 s78, s78, 2621440
    s_and_b32 s91, s13, 7
    s_mul_i32 s91, s91, 20480
    s_add_u32 s91, s91, s78
    s_add_u32 m0, s89, 65536
    s_nop 0
    buffer_load_dwordx4 v8, s[60:63], s91 offen sc1 lds
    buffer_load_dwordx4 v9, s[60:63], s91 offen offset:1024 sc1 lds
    buffer_load_dwordx4 v10, s[60:63], s91 offen offset:2048 sc1 lds
    buffer_load_dwordx4 v11, s[60:63], s91 offen offset:3072 sc1 lds
    s_add_u32 m0, s89, 69632
    s_nop 0
    buffer_load_dwordx4 v12, s[60:63], s91 offen sc1 lds
    s_add_u32 s13, s13, 1
    s_and_b32 s13, s13, 15
    s_waitcnt vmcnt(18)
    s_barrier
    s_cmp_lt_u32 s12, 8
    s_cselect_b32 s8, s36, s40
    s_cselect_b32 s9, s37, s41
    s_and_b32 s90, s12, 7
    s_lshl_b32 s90, s90, 7
    s_add_u32 m0, s88, 16384
    s_nop 0
    buffer_load_dwordx4 v4, s[8:11], s90 offen lds
    buffer_load_dwordx4 v5, s[8:11], s90 offen offset:1024 lds
    buffer_load_dwordx4 v6, s[8:11], s90 offen offset:2048 lds
    buffer_load_dwordx4 v7, s[8:11], s90 offen offset:3072 lds
    s_add_u32 s12, s12, 1
    s_and_b32 s12, s12, 15
    s_lshr_b32 s78, s13, 3
    s_mul_i32 s78, s78, 2621440
    s_and_b32 s91, s13, 7
    s_mul_i32 s91, s91, 20480
    s_add_u32 s91, s91, s78
    s_add_u32 m0, s89, 86016
    s_nop 0
    buffer_load_dwordx4 v8, s[60:63], s91 offen sc1 lds
    buffer_load_dwordx4 v9, s[60:63], s91 offen offset:1024 sc1 lds
    buffer_load_dwordx4 v10, s[60:63], s91 offen offset:2048 sc1 lds
    buffer_load_dwordx4 v11, s[60:63], s91 offen offset:3072 sc1 lds
    s_add_u32 m0, s89, 90112
    s_nop 0
    buffer_load_dwordx4 v12, s[60:63], s91 offen sc1 lds
    s_add_u32 s13, s13, 1
    s_and_b32 s13, s13, 15
    s_waitcnt vmcnt(18)
    s_barrier
    s_cmp_lt_u32 s12, 8
    s_cselect_b32 s8, s36, s40
    s_cselect_b32 s9, s37, s41
    s_and_b32 s90, s12, 7
    s_lshl_b32 s90, s90, 7
    s_add_u32 m0, s88, 32768
    s_nop 0
    buffer_load_dwordx4 v4, s[8:11], s90 offen lds
    buffer_load_dwordx4 v5, s[8:11], s90 offen offset:1024 lds
    buffer_load_dwordx4 v6, s[8:11], s90 offen offset:2048 lds
    buffer_load_dwordx4 v7, s[8:11], s90 offen offset:3072 lds
    s_add_u32 s12, s12, 1
    s_and_b32 s12, s12, 15
    s_lshr_b32 s78, s13, 3
    s_mul_i32 s78, s78, 2621440
    s_and_b32 s91, s13, 7
    s_mul_i32 s91, s91, 20480
    s_add_u32 s91, s91, s78
    s_add_u32 m0, s89, 106496
    s_nop 0
    buffer_load_dwordx4 v8, s[60:63], s91 offen sc1 lds
    buffer_load_dwordx4 v9, s[60:63], s91 offen offset:1024 sc1 lds
    buffer_load_dwordx4 v10, s[60:63], s91 offen offset:2048 sc1 lds
    buffer_load_dwordx4 v11, s[60:63], s91 offen offset:3072 sc1 lds
    s_add_u32 m0, s89, 110592
    s_nop 0
    buffer_load_dwordx4 v12, s[60:63], s91 offen sc1 lds
    s_add_u32 s13, s13, 1
    s_and_b32 s13, s13, 15
    s_waitcnt vmcnt(18)
    s_barrier
    s_cmp_lt_u32 s12, 8
    s_cselect_b32 s8, s36, s40
    s_cselect_b32 s9, s37, s41
    s_and_b32 s90, s12, 7
    s_lshl_b32 s90, s90, 7
    s_add_u32 m0, s88, 49152
    s_nop 0
    buffer_load_dwordx4 v4, s[8:11], s90 offen lds
    buffer_load_dwordx4 v5, s[8:11], s90 offen offset:1024 lds
    buffer_load_dwordx4 v6, s[8:11], s90 offen offset:2048 lds
    buffer_load_dwordx4 v7, s[8:11], s90 offen offset:3072 lds
    s_add_u32 s12, s12, 1
    s_and_b32 s12, s12, 15
    s_lshr_b32 s78, s13, 3
    s_mul_i32 s78, s78, 2621440
    s_and_b32 s91, s13, 7
    s_mul_i32 s91, s91, 20480
    s_add_u32 s91, s91, s78
    s_add_u32 m0, s89, 126976
    s_nop 0
    buffer_load_dwordx4 v8, s[60:63], s91 offen sc1 lds
    buffer_load_dwordx4 v9, s[60:63], s91 offen offset:1024 sc1 lds
    buffer_load_dwordx4 v10, s[60:63], s91 offen offset:2048 sc1 lds
    buffer_load_dwordx4 v11, s[60:63], s91 offen offset:3072 sc1 lds
    s_add_u32 m0, s89, 131072
    s_nop 0
    buffer_load_dwordx4 v12, s[60:63], s91 offen sc1 lds
    s_add_u32 s13, s13, 1
    s_and_b32 s13, s13, 15
    s_waitcnt vmcnt(18)
    s_barrier
    s_cmp_lt_u32 s12, 8
    s_cselect_b32 s8, s36, s40
    s_cselect_b32 s9, s37, s41
    s_and_b32 s90, s12, 7
    s_lshl_b32 s90, s90, 7
    s_add_u32 m0, s88, 0
    s_nop 0
    buffer_load_dwordx4 v4, s[8:11], s90 offen lds
    buffer_load_dwordx4 v5, s[8:11], s90 offen offset:1024 lds
    buffer_load_dwordx4 v6, s[8:11], s90 offen offset:2048 lds
    buffer_load_dwordx4 v7, s[8:11], s90 offen offset:3072 lds
    s_add_u32 s12, s12, 1
    s_and_b32 s12, s12, 15
    s_lshr_b32 s78, s13, 3
    s_mul_i32 s78, s78, 2621440
    s_and_b32 s91, s13, 7
    s_mul_i32 s91, s91, 20480
    s_add_u32 s91, s91, s78
    s_add_u32 m0, s89, 65536
    s_nop 0
    buffer_load_dwordx4 v8, s[60:63], s91 offen sc1 lds
    buffer_load_dwordx4 v9, s[60:63], s91 offen offset:1024 sc1 lds
    buffer_load_dwordx4 v10, s[60:63], s91 offen offset:2048 sc1 lds
    buffer_load_dwordx4 v11, s[60:63], s91 offen offset:3072 sc1 lds
    s_add_u32 m0, s89, 69632
    s_nop 0
    buffer_load_dwordx4 v12, s[60:63], s91 offen sc1 lds
    s_add_u32 s13, s13, 1
    s_and_b32 s13, s13, 15
    s_waitcnt vmcnt(18)
    s_barrier
    s_cmp_lt_u32 s12, 8
    s_cselect_b32 s8, s36, s40
    s_cselect_b32 s9, s37, s41
    s_and_b32 s90, s12, 7
    s_lshl_b32 s90, s90, 7
    s_add_u32 m0, s88, 16384
    s_nop 0
    buffer_load_dwordx4 v4, s[8:11], s90 offen lds
    buffer_load_dwordx4 v5, s[8:11], s90 offen offset:1024 lds
    buffer_load_dwordx4 v6, s[8:11], s90 offen offset:2048 lds
    buffer_load_dwordx4 v7, s[8:11], s90 offen offset:3072 lds
    s_add_u32 s12, s12, 1
    s_and_b32 s12, s12, 15
    s_lshr_b32 s78, s13, 3
    s_mul_i32 s78, s78, 2621440
    s_and_b32 s91, s13, 7
    s_mul_i32 s91, s91, 20480
    s_add_u32 s91, s91, s78
    s_add_u32 m0, s89, 86016
    s_nop 0
    buffer_load_dwordx4 v8, s[60:63], s91 offen sc1 lds
    buffer_load_dwordx4 v9, s[60:63], s91 offen offset:1024 sc1 lds
    buffer_load_dwordx4 v10, s[60:63], s91 offen offset:2048 sc1 lds
    buffer_load_dwordx4 v11, s[60:63], s91 offen offset:3072 sc1 lds
    s_add_u32 m0, s89, 90112
    s_nop 0
    buffer_load_dwordx4 v12, s[60:63], s91 offen sc1 lds
    s_add_u32 s13, s13, 1
    s_and_b32 s13, s13, 15
    s_andn2_b32 s78, s2, 0x18
    v_and_b32 v16, 3, v0
    v_lshlrev_b32 v17, 3, v16
    v_add_u32 v17, s78, v17
    v_xor_b32 v18, s2, v16
    v_and_b32 v19, 4, v0
    v_cmp_eq_u32 vcc, 0, v19
    s_nop 1
    v_cndmask_b32 v64, v18, v17, vcc
    v_lshlrev_b32 v64, 7, v64
    v_add_u32 v64, 32505872, v64
    buffer_load_dwordx4 v[72:75], v64, s[60:63], 0 offen sc1
    s_waitcnt vmcnt(19)
    s_barrier
    s_cmp_lt_u32 s12, 8
    s_cselect_b32 s8, s36, s40
    s_cselect_b32 s9, s37, s41
    s_and_b32 s90, s12, 7
    s_lshl_b32 s90, s90, 7
    s_add_u32 m0, s88, 32768
    s_nop 0
    buffer_load_dwordx4 v4, s[8:11], s90 offen lds
    buffer_load_dwordx4 v5, s[8:11], s90 offen offset:1024 lds
    buffer_load_dwordx4 v6, s[8:11], s90 offen offset:2048 lds
    buffer_load_dwordx4 v7, s[8:11], s90 offen offset:3072 lds
    s_add_u32 s12, s12, 1
    s_and_b32 s12, s12, 15
    s_lshr_b32 s78, s13, 3
    s_mul_i32 s78, s78, 2621440
    s_and_b32 s91, s13, 7
    s_mul_i32 s91, s91, 20480
    s_add_u32 s91, s91, s78
    s_add_u32 m0, s89, 106496
    s_nop 0
    buffer_load_dwordx4 v8, s[60:63], s91 offen sc1 lds
    buffer_load_dwordx4 v9, s[60:63], s91 offen offset:1024 sc1 lds
    buffer_load_dwordx4 v10, s[60:63], s91 offen offset:2048 sc1 lds
    buffer_load_dwordx4 v11, s[60:63], s91 offen offset:3072 sc1 lds
    s_add_u32 m0, s89, 110592
    s_nop 0
    buffer_load_dwordx4 v12, s[60:63], s91 offen sc1 lds
    s_add_u32 s13, s13, 1
    s_and_b32 s13, s13, 15
    s_waitcnt vmcnt(19)
    s_barrier
    s_cmp_lt_u32 s12, 8
    s_cselect_b32 s8, s36, s40
    s_cselect_b32 s9, s37, s41
    s_and_b32 s90, s12, 7
    s_lshl_b32 s90, s90, 7
    s_add_u32 m0, s88, 49152
    s_nop 0
    buffer_load_dwordx4 v4, s[8:11], s90 offen lds
    buffer_load_dwordx4 v5, s[8:11], s90 offen offset:1024 lds
    buffer_load_dwordx4 v6, s[8:11], s90 offen offset:2048 lds
    buffer_load_dwordx4 v7, s[8:11], s90 offen offset:3072 lds
    s_add_u32 s12, s12, 1
    s_and_b32 s12, s12, 15
    s_lshr_b32 s78, s13, 3
    s_mul_i32 s78, s78, 2621440
    s_and_b32 s91, s13, 7
    s_mul_i32 s91, s91, 20480
    s_add_u32 s91, s91, s78
    s_add_u32 m0, s89, 126976
    s_nop 0
    buffer_load_dwordx4 v8, s[60:63], s91 offen sc1 lds
    buffer_load_dwordx4 v9, s[60:63], s91 offen offset:1024 sc1 lds
    buffer_load_dwordx4 v10, s[60:63], s91 offen offset:2048 sc1 lds
    buffer_load_dwordx4 v11, s[60:63], s91 offen offset:3072 sc1 lds
    s_add_u32 m0, s89, 131072
    s_nop 0
    buffer_load_dwordx4 v12, s[60:63], s91 offen sc1 lds
    s_add_u32 s13, s13, 1
    s_and_b32 s13, s13, 15
    s_waitcnt vmcnt(19)
    s_barrier
    s_mul_i32 s78, s73, 48
    s_mul_i32 s79, s72, 12
    s_add_u32 s78, s78, s79
    s_lshl_b32 s78, s78, 13
    s_add_u32 s78, s78, 5242880
    s_lshl_b32 s79, s87, 12
    s_add_u32 s78, s78, s79
    v_lshlrev_b32 v16, 4, v0
    s_xor_b32 s79, s72, 0
    s_lshl_b32 s79, s79, 10
    s_add_u32 s79, s79, s78
    s_sub_u32 s79, s79, 0
    v_add_u32 v4, s79, v16
    s_xor_b32 s79, s72, 1
    s_lshl_b32 s79, s79, 10
    s_add_u32 s79, s79, s78
    s_sub_u32 s79, s79, 1024
    v_add_u32 v5, s79, v16
    s_xor_b32 s79, s72, 2
    s_lshl_b32 s79, s79, 10
    s_add_u32 s79, s79, s78
    s_sub_u32 s79, s79, 2048
    v_add_u32 v6, s79, v16
    s_xor_b32 s79, s72, 3
    s_lshl_b32 s79, s79, 10
    s_add_u32 s79, s79, s78
    s_sub_u32 s79, s79, 3072
    v_add_u32 v7, s79, v16
    s_and_b32 s15, s73, 7
    s_mul_i32 s15, s15, 3
    s_lshr_b32 s15, s15, 2
    s_mul_i32 s78, s74, 3
    s_lshr_b32 s78, s78, 1
    s_add_u32 s15, s15, s78
    s_sub_u32 s78, s15, 6
    s_cmp_ge_u32 s15, 6
    s_cselect_b32 s15, s78, s15
    s_mul_i32 s90, s15, 16384
    s_waitcnt vmcnt(18)
    v_and_b32 v72, v72, v73
    v_and_b32 v74, v74, v75
    v_and_b32 v72, v72, v74
    v_cmp_ne_u32 vcc, 1, v72
    s_cbranch_vccz Lok_44
    s_mov_b32 s92, 0x20000
Lpoll_45:
    buffer_load_dwordx4 v[72:75], v64, s[60:63], 0 offen sc1
    s_waitcnt vmcnt(0)
    v_and_b32 v72, v72, v73
    v_and_b32 v74, v74, v75
    v_and_b32 v72, v72, v74
    v_cmp_ne_u32 vcc, 1, v72
    s_cbranch_vccz Lpd_46
    s_sleep 8
    s_sub_u32 s92, s92, 1
    s_cmp_lg_u32 s92, 0
    s_cbranch_scc1 Lpoll_45
Lpd_46:
Lok_44:
    s_add_u32 m0, s88, 0
    s_nop 0
    buffer_load_dwordx4 v4, s[60:63], s90 offen sc1 lds
    buffer_load_dwordx4 v5, s[60:63], s90 offen offset:1024 sc1 lds
    buffer_load_dwordx4 v6, s[60:63], s90 offen offset:2048 sc1 lds
    buffer_load_dwordx4 v7, s[60:63], s90 offen offset:3072 sc1 lds
    s_add_u32 s90, s90, 16384
    s_cmp_eq_u32 s90, 98304
    s_cselect_b32 s90, 0, s90
    s_mul_i32 s78, s72, 491520
    s_mul_i32 s79, s74, 320
    s_add_u32 s78, s78, s79
    s_mul_i32 s79, s87, 80
    v_lshrrev_b32 v16, 2, v0
    v_add_u32 v16, s79, v16
    v_and_b32 v17, 3, v0
    v_add_u32 v18, 0, v16
    v_mul_u32_u24 v19, 52429, v18
    v_lshrrev_b32 v19, 18, v19
    v_mul_u32_u24 v20, 5, v19
    v_sub_u32 v20, v18, v20
    v_lshrrev_b32 v21, 1, v19
    v_and_b32 v21, 2, v21
    v_xor_b32 v21, v21, v17
    v_mul_u32_u24 v19, 1280, v19
    v_lshl_add_u32 v19, v20, 6, v19
    v_lshl_add_u32 v19, v21, 4, v19
    v_add_u32 v19, s78, v19
    v_subrev_u32 v8, 0, v19
    v_add_u32 v18, 16, v16
    v_mul_u32_u24 v19, 52429, v18
    v_lshrrev_b32 v19, 18, v19
    v_mul_u32_u24 v20, 5, v19
    v_sub_u32 v20, v18, v20
    v_lshrrev_b32 v21, 1, v19
    v_and_b32 v21, 2, v21
    v_xor_b32 v21, v21, v17
    v_mul_u32_u24 v19, 1280, v19
    v_lshl_add_u32 v19, v20, 6, v19
    v_lshl_add_u32 v19, v21, 4, v19
    v_add_u32 v19, s78, v19
    v_subrev_u32 v9, 1024, v19
    v_add_u32 v18, 32, v16
    v_mul_u32_u24 v19, 52429, v18
    v_lshrrev_b32 v19, 18, v19
    v_mul_u32_u24 v20, 5, v19
    v_sub_u32 v20, v18, v20
    v_lshrrev_b32 v21, 1, v19
    v_and_b32 v21, 2, v21
    v_xor_b32 v21, v21, v17
    v_mul_u32_u24 v19, 1280, v19
    v_lshl_add_u32 v19, v20, 6, v19
    v_lshl_add_u32 v19, v21, 4, v19
    v_add_u32 v19, s78, v19
    v_subrev_u32 v10, 2048, v19
    v_add_u32 v18, 48, v16
    v_mul_u32_u24 v19, 52429, v18
    v_lshrrev_b32 v19, 18, v19
    v_mul_u32_u24 v20, 5, v19
    v_sub_u32 v20, v18, v20
    v_lshrrev_b32 v21, 1, v19
    v_and_b32 v21, 2, v21
    v_xor_b32 v21, v21, v17
    v_mul_u32_u24 v19, 1280, v19
    v_lshl_add_u32 v19, v20, 6, v19
    v_lshl_add_u32 v19, v21, 4, v19
    v_add_u32 v19, s78, v19
    v_subrev_u32 v11, 3072, v19
    v_add_u32 v18, 64, v16
    v_mul_u32_u24 v19, 52429, v18
    v_lshrrev_b32 v19, 18, v19
    v_mul_u32_u24 v20, 5, v19
    v_sub_u32 v20, v18, v20
    v_lshrrev_b32 v21, 1, v19
    v_and_b32 v21, 2, v21
    v_xor_b32 v21, v21, v17
    v_mul_u32_u24 v19, 1280, v19
    v_lshl_add_u32 v19, v20, 6, v19
    v_lshl_add_u32 v19, v21, 4, v19
    v_add_u32 v19, s78, v19
    v_subrev_u32 v12, 0, v19
    s_mul_i32 s89, s87, 5120
    s_and_b32 s15, s73, 7
    s_mul_i32 s15, s15, 3
    s_lshr_b32 s15, s15, 2
    s_mul_i32 s78, s74, 3
    s_lshr_b32 s78, s78, 1
    s_add_u32 s15, s15, s78
    s_sub_u32 s78, s15, 6
    s_cmp_ge_u32 s15, 6
    s_cselect_b32 s15, s78, s15
    s_mul_i32 s91, s15, 81920
    s_add_u32 m0, s89, 65536
    s_nop 0
    buffer_load_dwordx4 v8, s[52:55], s91 offen lds
    buffer_load_dwordx4 v9, s[52:55], s91 offen offset:1024 lds
    buffer_load_dwordx4 v10, s[52:55], s91 offen offset:2048 lds
    buffer_load_dwordx4 v11, s[52:55], s91 offen offset:3072 lds
    s_add_u32 m0, s89, 69632
    s_nop 0
    buffer_load_dwordx4 v12, s[52:55], s91 offen lds
    s_add_u32 s91, s91, 81920
    s_cmp_eq_u32 s91, 491520
    s_cselect_b32 s91, 0, s91
    s_waitcnt vmcnt(18)
    s_barrier
    s_add_u32 m0, s88, 16384
    s_nop 0
    buffer_load_dwordx4 v4, s[60:63], s90 offen sc1 lds
    buffer_load_dwordx4 v5, s[60:63], s90 offen offset:1024 sc1 lds
    buffer_load_dwordx4 v6, s[60:63], s90 offen offset:2048 sc1 lds
    buffer_load_dwordx4 v7, s[60:63], s90 offen offset:3072 sc1 lds
    s_add_u32 s90, s90, 16384
    s_cmp_eq_u32 s90, 98304
    s_cselect_b32 s90, 0, s90
    s_add_u32 m0, s89, 86016
    s_nop 0
    buffer_load_dwordx4 v8, s[52:55], s91 offen lds
    buffer_load_dwordx4 v9, s[52:55], s91 offen offset:1024 lds
    buffer_load_dwordx4 v10, s[52:55], s91 offen offset:2048 lds
    buffer_load_dwordx4 v11, s[52:55], s91 offen offset:3072 lds
    s_add_u32 m0, s89, 90112
    s_nop 0
    buffer_load_dwordx4 v12, s[52:55], s91 offen lds
    s_add_u32 s91, s91, 81920
    s_cmp_eq_u32 s91, 491520
    s_cselect_b32 s91, 0, s91
    s_waitcnt vmcnt(18)
    s_barrier
    s_add_u32 m0, s88, 32768
    s_nop 0
    buffer_load_dwordx4 v4, s[60:63], s90 offen sc1 lds
    buffer_load_dwordx4 v5, s[60:63], s90 offen offset:1024 sc1 lds
    buffer_load_dwordx4 v6, s[60:63], s90 offen offset:2048 sc1 lds
    buffer_load_dwordx4 v7, s[60:63], s90 offen offset:3072 sc1 lds
    s_add_u32 s90, s90, 16384
    s_cmp_eq_u32 s90, 98304
    s_cselect_b32 s90, 0, s90
    s_add_u32 m0, s89, 106496
    s_nop 0
    buffer_load_dwordx4 v8, s[52:55], s91 offen lds
    buffer_load_dwordx4 v9, s[52:55], s91 offen offset:1024 lds
    buffer_load_dwordx4 v10, s[52:55], s91 offen offset:2048 lds
    buffer_load_dwordx4 v11, s[52:55], s91 offen offset:3072 lds
    s_add_u32 m0, s89, 110592
    s_nop 0
    buffer_load_dwordx4 v12, s[52:55], s91 offen lds
    s_add_u32 s91, s91, 81920
    s_cmp_eq_u32 s91, 491520
    s_cselect_b32 s91, 0, s91
    s_barrier
    s_add_u32 m0, s88, 49152
    s_nop 0
    buffer_load_dwordx4 v4, s[60:63], s90 offen sc1 lds
    buffer_load_dwordx4 v5, s[60:63], s90 offen offset:1024 sc1 lds
    buffer_load_dwordx4 v6, s[60:63], s90 offen offset:2048 sc1 lds
    buffer_load_dwordx4 v7, s[60:63], s90 offen offset:3072 sc1 lds
    s_add_u32 s90, s90, 16384
    s_cmp_eq_u32 s90, 98304
    s_cselect_b32 s90, 0, s90
    s_add_u32 m0, s89, 126976
    s_nop 0
    buffer_load_dwordx4 v8, s[52:55], s91 offen lds
    buffer_load_dwordx4 v9, s[52:55], s91 offen offset:1024 lds
    buffer_load_dwordx4 v10, s[52:55], s91 offen offset:2048 lds
    buffer_load_dwordx4 v11, s[52:55], s91 offen offset:3072 lds
    s_add_u32 m0, s89, 131072
    s_nop 0
    buffer_load_dwordx4 v12, s[52:55], s91 offen lds
    s_add_u32 s91, s91, 81920
    s_cmp_eq_u32 s91, 491520
    s_cselect_b32 s91, 0, s91
    s_waitcnt vmcnt(27)
    s_barrier
    s_waitcnt vmcnt(18)
    s_barrier
    s_add_u32 m0, s88, 0
    s_nop 0
    buffer_load_dwordx4 v4, s[60:63], s90 offen sc1 lds
    buffer_load_dwordx4 v5, s[60:63], s90 offen offset:1024 sc1 lds
    buffer_load_dwordx4 v6, s[60:63], s90 offen offset:2048 sc1 lds
    buffer_load_dwordx4 v7, s[60:63], s90 offen offset:3072 sc1 lds
    s_add_u32 s90, s90, 16384
    s_cmp_eq_u32 s90, 98304
    s_cselect_b32 s90, 0, s90
    s_add_u32 m0, s89, 65536
    s_nop 0
    buffer_load_dwordx4 v8, s[52:55], s91 offen lds
    buffer_load_dwordx4 v9, s[52:55], s91 offen offset:1024 lds
    buffer_load_dwordx4 v10, s[52:55], s91 offen offset:2048 lds
    buffer_load_dwordx4 v11, s[52:55], s91 offen offset:3072 lds
    s_add_u32 m0, s89, 69632
    s_nop 0
    buffer_load_dwordx4 v12, s[52:55], s91 offen lds
    s_add_u32 s91, s91, 81920
    s_cmp_eq_u32 s91, 491520
    s_cselect_b32 s91, 0, s91
    s_waitcnt vmcnt(18)
    s_barrier
    s_add_u32 m0, s88, 16384
    s_nop 0
    buffer_load_dwordx4 v4, s[60:63], s90 offen sc1 lds
    buffer_load_dwordx4 v5, s[60:63], s90 offen offset:1024 sc1 lds
    buffer_load_dwordx4 v6, s[60:63], s90 offen offset:2048 sc1 lds
    buffer_load_dwordx4 v7, s[60:63], s90 offen offset:3072 sc1 lds
    s_add_u32 s90, s90, 16384
    s_cmp_eq_u32 s90, 98304
    s_cselect_b32 s90, 0, s90
    s_add_u32 m0, s89, 86016
    s_nop 0
    buffer_load_dwordx4 v8, s[52:55], s91 offen lds
    buffer_load_dwordx4 v9, s[52:55], s91 offen offset:1024 lds
    buffer_load_dwordx4 v10, s[52:55], s91 offen offset:2048 lds
    buffer_load_dwordx4 v11, s[52:55], s91 offen offset:3072 lds
    s_add_u32 m0, s89, 90112
    s_nop 0
    buffer_load_dwordx4 v12, s[52:55], s91 offen lds
    s_add_u32 s91, s91, 81920
    s_cmp_eq_u32 s91, 491520
    s_cselect_b32 s91, 0, s91
    s_waitcnt vmcnt(18)
    s_barrier
    s_waitcnt vmcnt(9)
    s_barrier
    s_waitcnt vmcnt(0)
    s_barrier
    s_barrier
    s_waitcnt vmcnt(0)
    s_endpgm
L_end:
    s_endpgm

.section .rodata,"a"
.p2align 6
.amdhsa_kernel gated_mix__spectral_fnet__glu_gated_glu__prompt_kernel
  .amdhsa_next_free_vgpr 256
  .amdhsa_next_free_sgpr 102
  .amdhsa_accum_offset 256
  .amdhsa_group_segment_fixed_size 0
  .amdhsa_kernarg_size 104
  .amdhsa_user_sgpr_count 2
  .amdhsa_user_sgpr_kernarg_segment_ptr 1
  .amdhsa_system_sgpr_workgroup_id_x 1
.end_amdhsa_kernel
```
